```python
import torch

def _softmax(x, axis=-1):
    return torch.softmax(x, dim=axis)
def _gelu(x):
    return torch.nn.functional.gelu(x, approximate="tanh")
def _silu(x):
    return torch.nn.functional.silu(x)
def _sigmoid(x):
    return torch.sigmoid(x)
def _layernorm(x, axis=-1, eps=1e-5):
    m = x.mean(dim=axis, keepdim=True)
    v = x.var(dim=axis, keepdim=True, unbiased=False)
    return (x - m) / torch.sqrt(v + eps)
def _scatter_add(tgt, idx, src, axis=0):
    return tgt.clone().index_add_(axis, idx, src)
def _segment_sum(src, seg, n):
    out = torch.zeros((n,) + src.shape[1:], dtype=src.dtype)
    return out.index_add_(0, seg, src)
def _pad(x, pw):
    flat = tuple(v for pair in reversed(pw) for v in pair)
    return torch.nn.functional.pad(x, flat)

kernel_name = 'standalone__gqa_block_cached__decode'

def setup_inputs():

    _w = (lambda a: (lambda t: t.to(torch.bfloat16) if t.is_floating_point() else t)(torch.as_tensor(a)))
    B, Sq, D = 1, 1, 640
    Hq, Hkv, Sk, Dh = 32, 32, 32768, 128
    assert Hq % Hkv == 0, (Hq, Hkv)
    return {
        "x": _w((lambda *s: torch.randn(*s, dtype=torch.bfloat16) * 0.8)(B, Sq, D)),
        "k_cache": _w((lambda *s: torch.randn(*s, dtype=torch.bfloat16) * 0.8)(B, Hkv, Sk, Dh)),
        "v_cache": _w((lambda *s: torch.randn(*s, dtype=torch.bfloat16) * 0.05)(B, Hkv, Sk, Dh)),
        "wq": _w((lambda *s: torch.randn(*s, dtype=torch.bfloat16) * 0.8)(D, Hq * Dh) * (D ** -0.5)),
        "wo": _w((lambda *s: torch.randn(*s, dtype=torch.bfloat16) * 0.05)(Hq * Dh, D) * ((Hq * Dh) ** -0.5)),
    }

def reference(x, k_cache, v_cache, wq, wo):
    B, Sq, D = x.shape
    Hq, Dh = 32, 128
    Hkv = k_cache.shape[1]
    rep = Hq // Hkv
    q = (lambda x, *d: x.permute(*d))((x @ wq).reshape(B, Sq, Hq, Dh), 0, 2, 1, 3)
    k = (lambda x, n, axis: torch.repeat_interleave(x, n, dim=axis))(k_cache, rep, axis=1)
    v = (lambda x, n, axis: torch.repeat_interleave(x, n, dim=axis))(v_cache, rep, axis=1)
    scores = torch.einsum("bhqd,bhkd->bhqk", q, k) * (Dh ** -0.5)
    p = _softmax(scores, axis=-1)
    o = torch.einsum("bhqk,bhkd->bhqd", p, v)
    return (lambda x, *d: x.permute(*d))(o, 0, 2, 1, 3).reshape(B, Sq, Hq * Dh) @ wo
```

```asm
; @launch grid=(256,1,1) block=(320,1,1) lds=25344
.amdgcn_target "amdgcn-amd-amdhsa--gfx950"
.text
.globl standalone__gqa_block_cached__decode_kernel
.p2align 8
.type standalone__gqa_block_cached__decode_kernel,@function
standalone__gqa_block_cached__decode_kernel:
  s_load_dwordx16 s[4:19], s[0:1], 0
  s_cmp_ge_u32 s2, 256
  s_cbranch_scc1 L_end
  v_lshrrev_b32 v1, 6, v0
  s_lshr_b32 s20, s2, 3
  v_readfirstlane_b32 s22, v1
  s_and_b32 s21, s2, 7
  v_and_b32 v0, 63, v0
  s_mul_i32 s42, s21, 5
  s_add_u32 s20, s20, s42
  s_and_b32 s20, s20, 31
  s_lshl_b32 s2, s20, 3
  s_or_b32 s2, s2, s21
  s_mov_b32 s59, 0x40000
  s_lshr_b32 s3, s21, 0
  s_mov_b32 s23, 0
  s_mov_b32 s57, s2
  s_sub_u32 s22, s22, 1
  s_cbranch_scc1 L_helper
  v_lshlrev_b32 v1, 4, v0
  s_lshl_b32 s48, s21, 2
  s_add_u32 s48, s48, s22
  s_mul_i32 s42, s20, 1
  s_add_u32 s48, s48, s42
  s_and_b32 s48, s48, 31
  s_lshl_b32 s48, s48, 12
  s_lshl_b32 s42, s20, 23
  s_waitcnt lgkmcnt(0)
  s_add_u32 s24, s6, s42
  s_addc_u32 s25, s7, 0
  s_mov_b32 s26, 8388608
  s_mov_b32 s27, 0x20000
  s_add_u32 s28, s8, s42
  s_addc_u32 s29, s9, 0
  s_mov_b32 s30, 8388608
  s_mov_b32 s31, 0x20000
  s_mov_b32 s50, s48
  buffer_load_dwordx4 v[64:67], v1, s[24:27], s50 offen offset:0 nt
  buffer_load_dwordx4 v[68:71], v1, s[24:27], s50 offen offset:1024 nt
  buffer_load_dwordx4 v[72:75], v1, s[24:27], s50 offen offset:2048 nt
  buffer_load_dwordx4 v[76:79], v1, s[24:27], s50 offen offset:3072 nt
  s_add_u32 s50, s48, 8192
  s_and_b32 s50, s50, 126976
  s_add_u32 s50, s50, 131072
  buffer_load_dwordx4 v[80:83], v1, s[24:27], s50 offen offset:0 nt
  s_barrier
  s_lshl_b32 s42, s20, 8
  s_add_u32 s40, s18, s42
  s_addc_u32 s41, s19, 0
  s_mov_b32 s62, 1040356334
  v_mov_b32 v6, 0xff800000
  v_mov_b32 v7, 0
  v_mov_b32 v8, 0
  v_mov_b32 v9, 0
  v_mov_b32 v10, 0
  v_mov_b32 v11, 0
  v_mov_b32 v12, 0
  v_mov_b32 v13, 0
  v_mov_b32 v14, 0
  v_mov_b32 v15, 0
  v_and_b32 v26, 15, v0
  v_lshlrev_b32 v26, 4, v26
  v_mov_b32 v27, 0
  s_mov_b32 s63, 3
  s_mov_b32 s51, 917504
  s_add_u32 s55, s48, 57344
  s_lshl_b32 s42, s22, 12
  s_add_u32 s42, s42, 8960
  v_and_b32 v29, 60, v0
  v_add_u32 v29, s42, v29
  v_add_u32 v28, 384, v29
  s_mov_b32 s32, s18
  s_mov_b32 s33, s19
  s_mov_b32 s34, 2359296
  s_mov_b32 s35, 0x20000
  s_mov_b32 s36, s12
  s_mov_b32 s37, s13
  s_mov_b32 s39, 0x20000
  s_cmp_eq_u32 s23, 0
  s_cselect_b32 s38, 5242880, 0
  s_lshl_b32 s56, s20, 7
  s_mul_i32 s42, s3, 16
  s_add_u32 s56, s56, s42
  s_mul_i32 s56, s56, 1280
  s_lshl_b32 s42, s22, 8
  s_add_u32 s56, s56, s42
  s_waitcnt vmcnt(4)
  buffer_load_dwordx4 v[84:87], v1, s[24:27], s50 offen offset:1024 nt
  s_waitcnt vmcnt(4)
  buffer_load_dwordx4 v[88:91], v1, s[24:27], s50 offen offset:2048 nt
  s_waitcnt vmcnt(4)
  buffer_load_dwordx4 v[92:95], v1, s[24:27], s50 offen offset:3072 nt
  s_add_u32 s50, s48, 16384
  s_and_b32 s50, s50, 126976
  s_add_u32 s50, s50, 262144
  s_waitcnt vmcnt(4)
  buffer_load_dwordx4 v[96:99], v1, s[24:27], s50 offen offset:0 nt
  s_waitcnt vmcnt(4)
  buffer_load_dwordx4 v[100:103], v1, s[24:27], s50 offen offset:1024 nt
  s_waitcnt vmcnt(4)
  buffer_load_dwordx4 v[104:107], v1, s[24:27], s50 offen offset:2048 nt
  s_waitcnt vmcnt(4)
  buffer_load_dwordx4 v[108:111], v1, s[24:27], s50 offen offset:3072 nt
  s_add_u32 s50, s48, 24576
  s_and_b32 s50, s50, 126976
  s_add_u32 s50, s50, 393216
  s_waitcnt vmcnt(4)
  buffer_load_dwordx4 v[112:115], v1, s[24:27], s50 offen offset:0 nt
  s_waitcnt vmcnt(4)
  buffer_load_dwordx4 v[116:119], v1, s[24:27], s50 offen offset:1024 nt
  s_waitcnt vmcnt(4)
  buffer_load_dwordx4 v[120:123], v1, s[24:27], s50 offen offset:2048 nt
  s_waitcnt vmcnt(4)
  buffer_load_dwordx4 v[124:127], v1, s[24:27], s50 offen offset:3072 nt
  s_add_u32 s50, s48, 32768
  s_and_b32 s50, s50, 126976
  s_add_u32 s50, s50, 524288
  s_waitcnt vmcnt(4)
  buffer_load_dwordx4 v[128:131], v1, s[24:27], s50 offen offset:0 nt
  s_waitcnt vmcnt(4)
  buffer_load_dwordx4 v[132:135], v1, s[24:27], s50 offen offset:1024 nt
  s_waitcnt vmcnt(4)
  buffer_load_dwordx4 v[136:139], v1, s[24:27], s50 offen offset:2048 nt
  s_waitcnt vmcnt(4)
  buffer_load_dwordx4 v[140:143], v1, s[24:27], s50 offen offset:3072 nt
  s_add_u32 s50, s48, 40960
  s_and_b32 s50, s50, 126976
  s_add_u32 s50, s50, 655360
  s_waitcnt vmcnt(4)
  buffer_load_dwordx4 v[144:147], v1, s[24:27], s50 offen offset:0 nt
  s_waitcnt vmcnt(4)
  buffer_load_dwordx4 v[148:151], v1, s[24:27], s50 offen offset:1024 nt
  s_waitcnt vmcnt(4)
  buffer_load_dwordx4 v[152:155], v1, s[24:27], s50 offen offset:2048 nt
  s_waitcnt vmcnt(4)
  buffer_load_dwordx4 v[156:159], v1, s[24:27], s50 offen offset:3072 nt
  s_add_u32 s50, s48, 49152
  s_and_b32 s50, s50, 126976
  s_add_u32 s50, s50, 786432
  s_waitcnt vmcnt(4)
  buffer_load_dwordx4 v[32:35], v1, s[24:27], s50 offen offset:0 nt
  s_waitcnt vmcnt(4)
  buffer_load_dwordx4 v[36:39], v1, s[24:27], s50 offen offset:1024 nt
  s_waitcnt vmcnt(4)
  buffer_load_dwordx4 v[40:43], v1, s[24:27], s50 offen offset:2048 nt
  s_waitcnt vmcnt(4)
  buffer_load_dwordx4 v[44:47], v1, s[24:27], s50 offen offset:3072 nt
  s_add_u32 s50, s48, 57344
  s_and_b32 s50, s50, 126976
  s_add_u32 s50, s50, 917504
  s_waitcnt vmcnt(4)
  buffer_load_dwordx4 v[48:51], v1, s[24:27], s50 offen offset:0 nt
L_qwait:
  ds_read_b128 v[20:23], v27 offset:384
  s_waitcnt lgkmcnt(0)
  v_readfirstlane_b32 s42, v20
  s_cmp_lg_u32 s42, 0
  s_cbranch_scc1 L_qok
  s_sleep 1
  s_sub_u32 s59, s59, 1
  s_cmp_gt_i32 s59, 0
  s_cbranch_scc1 L_qwait
L_qok:
  ds_read_b128 v[2:5], v26 offset:0
  v_readfirstlane_b32 s60, v22
  v_readfirstlane_b32 s61, v23
  s_waitcnt lgkmcnt(0)
  s_branch L_kentry
L_extras:
  s_cmp_lg_u32 s63, 3
  s_cbranch_scc1 L_ex1
  v_mov_b32 v16, 0
  v_dot2c_f32_bf16 v16, v64, v2
  v_dot2c_f32_bf16 v16, v65, v3
  v_dot2c_f32_bf16 v16, v66, v4
  v_dot2c_f32_bf16 v16, v67, v5
  v_mov_b32 v17, 0
  v_dot2c_f32_bf16 v17, v68, v2
  v_dot2c_f32_bf16 v17, v69, v3
  v_dot2c_f32_bf16 v17, v70, v4
  v_dot2c_f32_bf16 v17, v71, v5
  v_mov_b32 v18, 0
  v_dot2c_f32_bf16 v18, v72, v2
  v_dot2c_f32_bf16 v18, v73, v3
  v_dot2c_f32_bf16 v18, v74, v4
  v_dot2c_f32_bf16 v18, v75, v5
  v_mov_b32 v19, 0
  v_dot2c_f32_bf16 v19, v76, v2
  v_dot2c_f32_bf16 v19, v77, v3
  v_dot2c_f32_bf16 v19, v78, v4
  v_dot2c_f32_bf16 v19, v79, v5
  v_add_f32_dpp v16, v16, v16 row_ror:8 row_mask:0xf bank_mask:0x3
  v_add_f32_dpp v17, v17, v17 row_ror:8 row_mask:0xf bank_mask:0x3
  v_add_f32_dpp v16, v18, v18 row_ror:8 row_mask:0xf bank_mask:0xc
  v_add_f32_dpp v17, v19, v19 row_ror:8 row_mask:0xf bank_mask:0xc
  s_nop 0
  v_add_f32_dpp v16, v16, v16 row_half_mirror row_mask:0xf bank_mask:0x5
  v_add_f32_dpp v16, v17, v17 row_half_mirror row_mask:0xf bank_mask:0xa
  s_nop 1
  v_add_f32_dpp v16, v16, v16 quad_perm:[1,0,3,2] row_mask:0xf bank_mask:0xf
  s_nop 1
  v_add_f32_dpp v16, v16, v16 quad_perm:[2,3,0,1] row_mask:0xf bank_mask:0xf
  v_max_f32 v6, v6, v16
  ds_write_b32 v29, v16 offset:0
  v_mov_b32 v16, 0
  v_dot2c_f32_bf16 v16, v80, v2
  v_dot2c_f32_bf16 v16, v81, v3
  v_dot2c_f32_bf16 v16, v82, v4
  v_dot2c_f32_bf16 v16, v83, v5
  v_mov_b32 v17, 0
  v_dot2c_f32_bf16 v17, v84, v2
  v_dot2c_f32_bf16 v17, v85, v3
  v_dot2c_f32_bf16 v17, v86, v4
  v_dot2c_f32_bf16 v17, v87, v5
  v_mov_b32 v18, 0
  v_dot2c_f32_bf16 v18, v88, v2
  v_dot2c_f32_bf16 v18, v89, v3
  v_dot2c_f32_bf16 v18, v90, v4
  v_dot2c_f32_bf16 v18, v91, v5
  v_mov_b32 v19, 0
  v_dot2c_f32_bf16 v19, v92, v2
  v_dot2c_f32_bf16 v19, v93, v3
  v_dot2c_f32_bf16 v19, v94, v4
  v_dot2c_f32_bf16 v19, v95, v5
  v_add_f32_dpp v16, v16, v16 row_ror:8 row_mask:0xf bank_mask:0x3
  v_add_f32_dpp v17, v17, v17 row_ror:8 row_mask:0xf bank_mask:0x3
  v_add_f32_dpp v16, v18, v18 row_ror:8 row_mask:0xf bank_mask:0xc
  v_add_f32_dpp v17, v19, v19 row_ror:8 row_mask:0xf bank_mask:0xc
  s_nop 0
  v_add_f32_dpp v16, v16, v16 row_half_mirror row_mask:0xf bank_mask:0x5
  v_add_f32_dpp v16, v17, v17 row_half_mirror row_mask:0xf bank_mask:0xa
  s_nop 1
  v_add_f32_dpp v16, v16, v16 quad_perm:[1,0,3,2] row_mask:0xf bank_mask:0xf
  s_nop 1
  v_add_f32_dpp v16, v16, v16 quad_perm:[2,3,0,1] row_mask:0xf bank_mask:0xf
  v_max_f32 v6, v6, v16
  ds_write_b32 v29, v16 offset:64
  s_mov_b32 s63, 2
  s_branch L_kentry
L_ex1:
  s_cmp_lg_u32 s63, 2
  s_cbranch_scc1 L_ex2
  v_mov_b32 v16, 0
  v_dot2c_f32_bf16 v16, v96, v2
  v_dot2c_f32_bf16 v16, v97, v3
  v_dot2c_f32_bf16 v16, v98, v4
  v_dot2c_f32_bf16 v16, v99, v5
  v_mov_b32 v17, 0
  v_dot2c_f32_bf16 v17, v100, v2
  v_dot2c_f32_bf16 v17, v101, v3
  v_dot2c_f32_bf16 v17, v102, v4
  v_dot2c_f32_bf16 v17, v103, v5
  v_mov_b32 v18, 0
  v_dot2c_f32_bf16 v18, v104, v2
  v_dot2c_f32_bf16 v18, v105, v3
  v_dot2c_f32_bf16 v18, v106, v4
  v_dot2c_f32_bf16 v18, v107, v5
  v_mov_b32 v19, 0
  v_dot2c_f32_bf16 v19, v108, v2
  v_dot2c_f32_bf16 v19, v109, v3
  v_dot2c_f32_bf16 v19, v110, v4
  v_dot2c_f32_bf16 v19, v111, v5
  v_add_f32_dpp v16, v16, v16 row_ror:8 row_mask:0xf bank_mask:0x3
  v_add_f32_dpp v17, v17, v17 row_ror:8 row_mask:0xf bank_mask:0x3
  v_add_f32_dpp v16, v18, v18 row_ror:8 row_mask:0xf bank_mask:0xc
  v_add_f32_dpp v17, v19, v19 row_ror:8 row_mask:0xf bank_mask:0xc
  s_nop 0
  v_add_f32_dpp v16, v16, v16 row_half_mirror row_mask:0xf bank_mask:0x5
  v_add_f32_dpp v16, v17, v17 row_half_mirror row_mask:0xf bank_mask:0xa
  s_nop 1
  v_add_f32_dpp v16, v16, v16 quad_perm:[1,0,3,2] row_mask:0xf bank_mask:0xf
  s_nop 1
  v_add_f32_dpp v16, v16, v16 quad_perm:[2,3,0,1] row_mask:0xf bank_mask:0xf
  v_max_f32 v6, v6, v16
  ds_write_b32 v29, v16 offset:128
  v_mov_b32 v16, 0
  v_dot2c_f32_bf16 v16, v112, v2
  v_dot2c_f32_bf16 v16, v113, v3
  v_dot2c_f32_bf16 v16, v114, v4
  v_dot2c_f32_bf16 v16, v115, v5
  v_mov_b32 v17, 0
  v_dot2c_f32_bf16 v17, v116, v2
  v_dot2c_f32_bf16 v17, v117, v3
  v_dot2c_f32_bf16 v17, v118, v4
  v_dot2c_f32_bf16 v17, v119, v5
  v_mov_b32 v18, 0
  v_dot2c_f32_bf16 v18, v120, v2
  v_dot2c_f32_bf16 v18, v121, v3
  v_dot2c_f32_bf16 v18, v122, v4
  v_dot2c_f32_bf16 v18, v123, v5
  v_mov_b32 v19, 0
  v_dot2c_f32_bf16 v19, v124, v2
  v_dot2c_f32_bf16 v19, v125, v3
  v_dot2c_f32_bf16 v19, v126, v4
  v_dot2c_f32_bf16 v19, v127, v5
  v_add_f32_dpp v16, v16, v16 row_ror:8 row_mask:0xf bank_mask:0x3
  v_add_f32_dpp v17, v17, v17 row_ror:8 row_mask:0xf bank_mask:0x3
  v_add_f32_dpp v16, v18, v18 row_ror:8 row_mask:0xf bank_mask:0xc
  v_add_f32_dpp v17, v19, v19 row_ror:8 row_mask:0xf bank_mask:0xc
  s_nop 0
  v_add_f32_dpp v16, v16, v16 row_half_mirror row_mask:0xf bank_mask:0x5
  v_add_f32_dpp v16, v17, v17 row_half_mirror row_mask:0xf bank_mask:0xa
  s_nop 1
  v_add_f32_dpp v16, v16, v16 quad_perm:[1,0,3,2] row_mask:0xf bank_mask:0xf
  s_nop 1
  v_add_f32_dpp v16, v16, v16 quad_perm:[2,3,0,1] row_mask:0xf bank_mask:0xf
  v_max_f32 v6, v6, v16
  ds_write_b32 v29, v16 offset:192
  s_mov_b32 s63, 1
  s_branch L_kentry
L_ex2:
  v_mov_b32 v16, 0
  v_dot2c_f32_bf16 v16, v128, v2
  v_dot2c_f32_bf16 v16, v129, v3
  v_dot2c_f32_bf16 v16, v130, v4
  v_dot2c_f32_bf16 v16, v131, v5
  v_mov_b32 v17, 0
  v_dot2c_f32_bf16 v17, v132, v2
  v_dot2c_f32_bf16 v17, v133, v3
  v_dot2c_f32_bf16 v17, v134, v4
  v_dot2c_f32_bf16 v17, v135, v5
  v_mov_b32 v18, 0
  v_dot2c_f32_bf16 v18, v136, v2
  v_dot2c_f32_bf16 v18, v137, v3
  v_dot2c_f32_bf16 v18, v138, v4
  v_dot2c_f32_bf16 v18, v139, v5
  v_mov_b32 v19, 0
  v_dot2c_f32_bf16 v19, v140, v2
  v_dot2c_f32_bf16 v19, v141, v3
  v_dot2c_f32_bf16 v19, v142, v4
  v_dot2c_f32_bf16 v19, v143, v5
  v_add_f32_dpp v16, v16, v16 row_ror:8 row_mask:0xf bank_mask:0x3
  v_add_f32_dpp v17, v17, v17 row_ror:8 row_mask:0xf bank_mask:0x3
  v_add_f32_dpp v16, v18, v18 row_ror:8 row_mask:0xf bank_mask:0xc
  v_add_f32_dpp v17, v19, v19 row_ror:8 row_mask:0xf bank_mask:0xc
  s_nop 0
  v_add_f32_dpp v16, v16, v16 row_half_mirror row_mask:0xf bank_mask:0x5
  v_add_f32_dpp v16, v17, v17 row_half_mirror row_mask:0xf bank_mask:0xa
  s_nop 1
  v_add_f32_dpp v16, v16, v16 quad_perm:[1,0,3,2] row_mask:0xf bank_mask:0xf
  s_nop 1
  v_add_f32_dpp v16, v16, v16 quad_perm:[2,3,0,1] row_mask:0xf bank_mask:0xf
  v_max_f32 v6, v6, v16
  ds_write_b32 v29, v16 offset:256
  v_mov_b32 v16, 0
  v_dot2c_f32_bf16 v16, v144, v2
  v_dot2c_f32_bf16 v16, v145, v3
  v_dot2c_f32_bf16 v16, v146, v4
  v_dot2c_f32_bf16 v16, v147, v5
  v_mov_b32 v17, 0
  v_dot2c_f32_bf16 v17, v148, v2
  v_dot2c_f32_bf16 v17, v149, v3
  v_dot2c_f32_bf16 v17, v150, v4
  v_dot2c_f32_bf16 v17, v151, v5
  v_mov_b32 v18, 0
  v_dot2c_f32_bf16 v18, v152, v2
  v_dot2c_f32_bf16 v18, v153, v3
  v_dot2c_f32_bf16 v18, v154, v4
  v_dot2c_f32_bf16 v18, v155, v5
  v_mov_b32 v19, 0
  v_dot2c_f32_bf16 v19, v156, v2
  v_dot2c_f32_bf16 v19, v157, v3
  v_dot2c_f32_bf16 v19, v158, v4
  v_dot2c_f32_bf16 v19, v159, v5
  v_add_f32_dpp v16, v16, v16 row_ror:8 row_mask:0xf bank_mask:0x3
  v_add_f32_dpp v17, v17, v17 row_ror:8 row_mask:0xf bank_mask:0x3
  v_add_f32_dpp v16, v18, v18 row_ror:8 row_mask:0xf bank_mask:0xc
  v_add_f32_dpp v17, v19, v19 row_ror:8 row_mask:0xf bank_mask:0xc
  s_nop 0
  v_add_f32_dpp v16, v16, v16 row_half_mirror row_mask:0xf bank_mask:0x5
  v_add_f32_dpp v16, v17, v17 row_half_mirror row_mask:0xf bank_mask:0xa
  s_nop 1
  v_add_f32_dpp v16, v16, v16 quad_perm:[1,0,3,2] row_mask:0xf bank_mask:0xf
  s_nop 1
  v_add_f32_dpp v16, v16, v16 quad_perm:[2,3,0,1] row_mask:0xf bank_mask:0xf
  v_max_f32 v6, v6, v16
  ds_write_b32 v29, v16 offset:320
  s_mov_b32 s63, 0
  s_branch L_kentry
L_kloop:
  s_add_u32 s51, s51, 131072
  s_add_u32 s55, s55, 8192
  s_and_b32 s50, s55, 126976
  s_add_u32 s50, s50, s51
  s_waitcnt vmcnt(4)
  buffer_load_dwordx4 v[32:35], v1, s[24:27], s50 offen offset:0 nt
  v_mov_b32 v19, 0
  v_dot2c_f32_bf16 v19, v44, v2
  v_dot2c_f32_bf16 v19, v45, v3
  v_dot2c_f32_bf16 v19, v46, v4
  v_dot2c_f32_bf16 v19, v47, v5
  v_add_f32_dpp v16, v16, v16 row_ror:8 row_mask:0xf bank_mask:0x3
  v_add_f32_dpp v17, v17, v17 row_ror:8 row_mask:0xf bank_mask:0x3
  v_add_f32_dpp v16, v18, v18 row_ror:8 row_mask:0xf bank_mask:0xc
  v_add_f32_dpp v17, v19, v19 row_ror:8 row_mask:0xf bank_mask:0xc
  s_nop 0
  v_add_f32_dpp v16, v16, v16 row_half_mirror row_mask:0xf bank_mask:0x5
  v_add_f32_dpp v16, v17, v17 row_half_mirror row_mask:0xf bank_mask:0xa
  s_nop 1
  v_add_f32_dpp v16, v16, v16 quad_perm:[1,0,3,2] row_mask:0xf bank_mask:0xf
  s_nop 1
  v_add_f32_dpp v16, v16, v16 quad_perm:[2,3,0,1] row_mask:0xf bank_mask:0xf
  v_max_f32 v6, v6, v16
  ds_write_b32 v28, v16 offset:0
  s_waitcnt vmcnt(4)
  buffer_load_dwordx4 v[36:39], v1, s[24:27], s50 offen offset:1024 nt
  v_mov_b32 v16, 0
  v_dot2c_f32_bf16 v16, v48, v2
  v_dot2c_f32_bf16 v16, v49, v3
  v_dot2c_f32_bf16 v16, v50, v4
  v_dot2c_f32_bf16 v16, v51, v5
  s_waitcnt vmcnt(4)
  buffer_load_dwordx4 v[40:43], v1, s[24:27], s50 offen offset:2048 nt
  v_mov_b32 v17, 0
  v_dot2c_f32_bf16 v17, v52, v2
  v_dot2c_f32_bf16 v17, v53, v3
  v_dot2c_f32_bf16 v17, v54, v4
  v_dot2c_f32_bf16 v17, v55, v5
  s_waitcnt vmcnt(4)
  buffer_load_dwordx4 v[44:47], v1, s[24:27], s50 offen offset:3072 nt
  v_mov_b32 v18, 0
  v_dot2c_f32_bf16 v18, v56, v2
  v_dot2c_f32_bf16 v18, v57, v3
  v_dot2c_f32_bf16 v18, v58, v4
  v_dot2c_f32_bf16 v18, v59, v5
  s_add_u32 s51, s51, 131072
  s_add_u32 s55, s55, 8192
  s_and_b32 s50, s55, 126976
  s_add_u32 s50, s50, s51
  s_waitcnt vmcnt(4)
  buffer_load_dwordx4 v[48:51], v1, s[24:27], s50 offen offset:0 nt
  v_mov_b32 v19, 0
  v_dot2c_f32_bf16 v19, v60, v2
  v_dot2c_f32_bf16 v19, v61, v3
  v_dot2c_f32_bf16 v19, v62, v4
  v_dot2c_f32_bf16 v19, v63, v5
  v_add_f32_dpp v16, v16, v16 row_ror:8 row_mask:0xf bank_mask:0x3
  v_add_f32_dpp v17, v17, v17 row_ror:8 row_mask:0xf bank_mask:0x3
  v_add_f32_dpp v16, v18, v18 row_ror:8 row_mask:0xf bank_mask:0xc
  v_add_f32_dpp v17, v19, v19 row_ror:8 row_mask:0xf bank_mask:0xc
  s_nop 0
  v_add_f32_dpp v16, v16, v16 row_half_mirror row_mask:0xf bank_mask:0x5
  v_add_f32_dpp v16, v17, v17 row_half_mirror row_mask:0xf bank_mask:0xa
  s_nop 1
  v_add_f32_dpp v16, v16, v16 quad_perm:[1,0,3,2] row_mask:0xf bank_mask:0xf
  s_nop 1
  v_add_f32_dpp v16, v16, v16 quad_perm:[2,3,0,1] row_mask:0xf bank_mask:0xf
  v_max_f32 v6, v6, v16
  ds_write_b32 v28, v16 offset:64
  v_add_u32 v28, 128, v28
  s_cmp_lg_u32 s63, 0
  s_cbranch_scc1 L_extras
L_kentry:
  s_waitcnt vmcnt(4)
  buffer_load_dwordx4 v[52:55], v1, s[24:27], s50 offen offset:1024 nt
  v_mov_b32 v16, 0
  v_dot2c_f32_bf16 v16, v32, v2
  v_dot2c_f32_bf16 v16, v33, v3
  v_dot2c_f32_bf16 v16, v34, v4
  v_dot2c_f32_bf16 v16, v35, v5
  s_waitcnt vmcnt(4)
  buffer_load_dwordx4 v[56:59], v1, s[24:27], s50 offen offset:2048 nt
  v_mov_b32 v17, 0
  v_dot2c_f32_bf16 v17, v36, v2
  v_dot2c_f32_bf16 v17, v37, v3
  v_dot2c_f32_bf16 v17, v38, v4
  v_dot2c_f32_bf16 v17, v39, v5
  s_waitcnt vmcnt(4)
  buffer_load_dwordx4 v[60:63], v1, s[24:27], s50 offen offset:3072 nt
  v_mov_b32 v18, 0
  v_dot2c_f32_bf16 v18, v40, v2
  v_dot2c_f32_bf16 v18, v41, v3
  v_dot2c_f32_bf16 v18, v42, v4
  v_dot2c_f32_bf16 v18, v43, v5
  s_cmp_lt_u32 s51, 7733248
  s_cbranch_scc1 L_kloop
  s_mov_b32 s51, 0
  s_mov_b32 s55, s48
  s_mov_b32 s50, s48
  s_waitcnt vmcnt(4)
  buffer_load_dwordx4 v[32:35], v1, s[28:31], s50 offen offset:0 nt
  v_mov_b32 v19, 0
  v_dot2c_f32_bf16 v19, v44, v2
  v_dot2c_f32_bf16 v19, v45, v3
  v_dot2c_f32_bf16 v19, v46, v4
  v_dot2c_f32_bf16 v19, v47, v5
  v_add_f32_dpp v16, v16, v16 row_ror:8 row_mask:0xf bank_mask:0x3
  v_add_f32_dpp v17, v17, v17 row_ror:8 row_mask:0xf bank_mask:0x3
  v_add_f32_dpp v16, v18, v18 row_ror:8 row_mask:0xf bank_mask:0xc
  v_add_f32_dpp v17, v19, v19 row_ror:8 row_mask:0xf bank_mask:0xc
  s_nop 0
  v_add_f32_dpp v16, v16, v16 row_half_mirror row_mask:0xf bank_mask:0x5
  v_add_f32_dpp v16, v17, v17 row_half_mirror row_mask:0xf bank_mask:0xa
  s_nop 1
  v_add_f32_dpp v16, v16, v16 quad_perm:[1,0,3,2] row_mask:0xf bank_mask:0xf
  s_nop 1
  v_add_f32_dpp v16, v16, v16 quad_perm:[2,3,0,1] row_mask:0xf bank_mask:0xf
  v_max_f32 v6, v6, v16
  ds_write_b32 v28, v16 offset:0
  s_waitcnt vmcnt(4)
  buffer_load_dwordx4 v[36:39], v1, s[28:31], s50 offen offset:1024 nt
  v_mov_b32 v16, 0
  v_dot2c_f32_bf16 v16, v48, v2
  v_dot2c_f32_bf16 v16, v49, v3
  v_dot2c_f32_bf16 v16, v50, v4
  v_dot2c_f32_bf16 v16, v51, v5
  s_waitcnt vmcnt(4)
  buffer_load_dwordx4 v[40:43], v1, s[28:31], s50 offen offset:2048 nt
  v_mov_b32 v17, 0
  v_dot2c_f32_bf16 v17, v52, v2
  v_dot2c_f32_bf16 v17, v53, v3
  v_dot2c_f32_bf16 v17, v54, v4
  v_dot2c_f32_bf16 v17, v55, v5
  s_waitcnt vmcnt(4)
  buffer_load_dwordx4 v[44:47], v1, s[28:31], s50 offen offset:3072 nt
  v_mov_b32 v18, 0
  v_dot2c_f32_bf16 v18, v56, v2
  v_dot2c_f32_bf16 v18, v57, v3
  v_dot2c_f32_bf16 v18, v58, v4
  v_dot2c_f32_bf16 v18, v59, v5
  s_add_u32 s51, s51, 131072
  s_add_u32 s55, s55, 8192
  s_and_b32 s50, s55, 126976
  s_add_u32 s50, s50, s51
  s_waitcnt vmcnt(4)
  buffer_load_dwordx4 v[48:51], v1, s[28:31], s50 offen offset:0 nt
  v_mov_b32 v19, 0
  v_dot2c_f32_bf16 v19, v60, v2
  v_dot2c_f32_bf16 v19, v61, v3
  v_dot2c_f32_bf16 v19, v62, v4
  v_dot2c_f32_bf16 v19, v63, v5
  v_add_f32_dpp v16, v16, v16 row_ror:8 row_mask:0xf bank_mask:0x3
  v_add_f32_dpp v17, v17, v17 row_ror:8 row_mask:0xf bank_mask:0x3
  v_add_f32_dpp v16, v18, v18 row_ror:8 row_mask:0xf bank_mask:0xc
  v_add_f32_dpp v17, v19, v19 row_ror:8 row_mask:0xf bank_mask:0xc
  s_nop 0
  v_add_f32_dpp v16, v16, v16 row_half_mirror row_mask:0xf bank_mask:0x5
  v_add_f32_dpp v16, v17, v17 row_half_mirror row_mask:0xf bank_mask:0xa
  s_nop 1
  v_add_f32_dpp v16, v16, v16 quad_perm:[1,0,3,2] row_mask:0xf bank_mask:0xf
  s_nop 1
  v_add_f32_dpp v16, v16, v16 quad_perm:[2,3,0,1] row_mask:0xf bank_mask:0xf
  v_max_f32 v6, v6, v16
  ds_write_b32 v28, v16 offset:64
  ds_read_b32 v31, v29
  v_max_f32_dpp v6, v6, v6 row_ror:8 row_mask:0xf bank_mask:0xf
  v_add_u32 v28, 64, v29
  s_nop 0
  v_max_f32_dpp v6, v6, v6 row_ror:4 row_mask:0xf bank_mask:0xf
  s_waitcnt lgkmcnt(0)
  s_branch L_ventry
L_vloop:
  s_add_u32 s51, s51, 131072
  s_add_u32 s55, s55, 8192
  s_and_b32 s50, s55, 126976
  s_add_u32 s50, s50, s51
  s_waitcnt vmcnt(4)
  buffer_load_dwordx4 v[32:35], v1, s[28:31], s50 offen offset:0 nt
  v_dot2c_f32_bf16_dpp v8, v21, v44 row_newbcast:12 row_mask:0xf bank_mask:0xf
  v_dot2c_f32_bf16_dpp v9, v22, v44 row_newbcast:12 row_mask:0xf bank_mask:0xf
  v_dot2c_f32_bf16_dpp v10, v21, v45 row_newbcast:12 row_mask:0xf bank_mask:0xf
  v_dot2c_f32_bf16_dpp v11, v22, v45 row_newbcast:12 row_mask:0xf bank_mask:0xf
  v_dot2c_f32_bf16_dpp v12, v21, v46 row_newbcast:12 row_mask:0xf bank_mask:0xf
  v_dot2c_f32_bf16_dpp v13, v22, v46 row_newbcast:12 row_mask:0xf bank_mask:0xf
  v_dot2c_f32_bf16_dpp v14, v21, v47 row_newbcast:12 row_mask:0xf bank_mask:0xf
  v_dot2c_f32_bf16_dpp v15, v22, v47 row_newbcast:12 row_mask:0xf bank_mask:0xf
  s_waitcnt vmcnt(4)
  buffer_load_dwordx4 v[36:39], v1, s[28:31], s50 offen offset:1024 nt
  s_waitcnt lgkmcnt(0)
  v_sub_f32 v20, v30, v6
  v_mul_f32 v20, s62, v20
  v_exp_f32 v20, v20
  s_nop 0
  v_cvt_pk_bf16_f32 v21, v20, 0
  v_cvt_pk_bf16_f32 v22, 0, v20
  v_add_f32 v7, v7, v20
  v_dot2c_f32_bf16_dpp v8, v21, v48 row_newbcast:0 row_mask:0xf bank_mask:0xf
  v_dot2c_f32_bf16_dpp v9, v22, v48 row_newbcast:0 row_mask:0xf bank_mask:0xf
  v_dot2c_f32_bf16_dpp v10, v21, v49 row_newbcast:0 row_mask:0xf bank_mask:0xf
  v_dot2c_f32_bf16_dpp v11, v22, v49 row_newbcast:0 row_mask:0xf bank_mask:0xf
  v_dot2c_f32_bf16_dpp v12, v21, v50 row_newbcast:0 row_mask:0xf bank_mask:0xf
  v_dot2c_f32_bf16_dpp v13, v22, v50 row_newbcast:0 row_mask:0xf bank_mask:0xf
  v_dot2c_f32_bf16_dpp v14, v21, v51 row_newbcast:0 row_mask:0xf bank_mask:0xf
  v_dot2c_f32_bf16_dpp v15, v22, v51 row_newbcast:0 row_mask:0xf bank_mask:0xf
  s_cmp_lt_u32 s51, 7602176
  s_cbranch_scc1 L_vnc
  s_mov_b32 s49, 1
  s_atomic_add s49, s[40:41], 0 glc
L_vnc:
  s_waitcnt vmcnt(4)
  buffer_load_dwordx4 v[40:43], v1, s[28:31], s50 offen offset:2048 nt
  v_dot2c_f32_bf16_dpp v8, v21, v52 row_newbcast:4 row_mask:0xf bank_mask:0xf
  v_dot2c_f32_bf16_dpp v9, v22, v52 row_newbcast:4 row_mask:0xf bank_mask:0xf
  v_dot2c_f32_bf16_dpp v10, v21, v53 row_newbcast:4 row_mask:0xf bank_mask:0xf
  v_dot2c_f32_bf16_dpp v11, v22, v53 row_newbcast:4 row_mask:0xf bank_mask:0xf
  v_dot2c_f32_bf16_dpp v12, v21, v54 row_newbcast:4 row_mask:0xf bank_mask:0xf
  v_dot2c_f32_bf16_dpp v13, v22, v54 row_newbcast:4 row_mask:0xf bank_mask:0xf
  v_dot2c_f32_bf16_dpp v14, v21, v55 row_newbcast:4 row_mask:0xf bank_mask:0xf
  v_dot2c_f32_bf16_dpp v15, v22, v55 row_newbcast:4 row_mask:0xf bank_mask:0xf
  s_waitcnt vmcnt(4)
  buffer_load_dwordx4 v[44:47], v1, s[28:31], s50 offen offset:3072 nt
  v_dot2c_f32_bf16_dpp v8, v21, v56 row_newbcast:8 row_mask:0xf bank_mask:0xf
  v_dot2c_f32_bf16_dpp v9, v22, v56 row_newbcast:8 row_mask:0xf bank_mask:0xf
  v_dot2c_f32_bf16_dpp v10, v21, v57 row_newbcast:8 row_mask:0xf bank_mask:0xf
  v_dot2c_f32_bf16_dpp v11, v22, v57 row_newbcast:8 row_mask:0xf bank_mask:0xf
  v_dot2c_f32_bf16_dpp v12, v21, v58 row_newbcast:8 row_mask:0xf bank_mask:0xf
  v_dot2c_f32_bf16_dpp v13, v22, v58 row_newbcast:8 row_mask:0xf bank_mask:0xf
  v_dot2c_f32_bf16_dpp v14, v21, v59 row_newbcast:8 row_mask:0xf bank_mask:0xf
  v_dot2c_f32_bf16_dpp v15, v22, v59 row_newbcast:8 row_mask:0xf bank_mask:0xf
  s_add_u32 s51, s51, 131072
  s_add_u32 s55, s55, 8192
  s_and_b32 s50, s55, 126976
  s_add_u32 s50, s50, s51
  s_waitcnt vmcnt(4)
  buffer_load_dwordx4 v[48:51], v1, s[28:31], s50 offen offset:0 nt
  v_dot2c_f32_bf16_dpp v8, v21, v60 row_newbcast:12 row_mask:0xf bank_mask:0xf
  v_dot2c_f32_bf16_dpp v9, v22, v60 row_newbcast:12 row_mask:0xf bank_mask:0xf
  v_dot2c_f32_bf16_dpp v10, v21, v61 row_newbcast:12 row_mask:0xf bank_mask:0xf
  v_dot2c_f32_bf16_dpp v11, v22, v61 row_newbcast:12 row_mask:0xf bank_mask:0xf
  v_dot2c_f32_bf16_dpp v12, v21, v62 row_newbcast:12 row_mask:0xf bank_mask:0xf
  v_dot2c_f32_bf16_dpp v13, v22, v62 row_newbcast:12 row_mask:0xf bank_mask:0xf
  v_dot2c_f32_bf16_dpp v14, v21, v63 row_newbcast:12 row_mask:0xf bank_mask:0xf
  v_dot2c_f32_bf16_dpp v15, v22, v63 row_newbcast:12 row_mask:0xf bank_mask:0xf
L_ventry:
  s_waitcnt vmcnt(4)
  buffer_load_dwordx4 v[52:55], v1, s[28:31], s50 offen offset:1024 nt
  v_sub_f32 v20, v31, v6
  v_mul_f32 v20, s62, v20
  v_exp_f32 v20, v20
  s_nop 0
  v_cvt_pk_bf16_f32 v21, v20, 0
  v_cvt_pk_bf16_f32 v22, 0, v20
  v_add_f32 v7, v7, v20
  v_dot2c_f32_bf16_dpp v8, v21, v32 row_newbcast:0 row_mask:0xf bank_mask:0xf
  v_dot2c_f32_bf16_dpp v9, v22, v32 row_newbcast:0 row_mask:0xf bank_mask:0xf
  v_dot2c_f32_bf16_dpp v10, v21, v33 row_newbcast:0 row_mask:0xf bank_mask:0xf
  v_dot2c_f32_bf16_dpp v11, v22, v33 row_newbcast:0 row_mask:0xf bank_mask:0xf
  v_dot2c_f32_bf16_dpp v12, v21, v34 row_newbcast:0 row_mask:0xf bank_mask:0xf
  v_dot2c_f32_bf16_dpp v13, v22, v34 row_newbcast:0 row_mask:0xf bank_mask:0xf
  v_dot2c_f32_bf16_dpp v14, v21, v35 row_newbcast:0 row_mask:0xf bank_mask:0xf
  v_dot2c_f32_bf16_dpp v15, v22, v35 row_newbcast:0 row_mask:0xf bank_mask:0xf
  ds_read2_b32 v[30:31], v28 offset0:0 offset1:16
  v_add_u32 v28, 128, v28
  s_waitcnt vmcnt(4)
  buffer_load_dwordx4 v[56:59], v1, s[28:31], s50 offen offset:2048 nt
  v_dot2c_f32_bf16_dpp v8, v21, v36 row_newbcast:4 row_mask:0xf bank_mask:0xf
  v_dot2c_f32_bf16_dpp v9, v22, v36 row_newbcast:4 row_mask:0xf bank_mask:0xf
  v_dot2c_f32_bf16_dpp v10, v21, v37 row_newbcast:4 row_mask:0xf bank_mask:0xf
  v_dot2c_f32_bf16_dpp v11, v22, v37 row_newbcast:4 row_mask:0xf bank_mask:0xf
  v_dot2c_f32_bf16_dpp v12, v21, v38 row_newbcast:4 row_mask:0xf bank_mask:0xf
  v_dot2c_f32_bf16_dpp v13, v22, v38 row_newbcast:4 row_mask:0xf bank_mask:0xf
  v_dot2c_f32_bf16_dpp v14, v21, v39 row_newbcast:4 row_mask:0xf bank_mask:0xf
  v_dot2c_f32_bf16_dpp v15, v22, v39 row_newbcast:4 row_mask:0xf bank_mask:0xf
  s_waitcnt vmcnt(4)
  buffer_load_dwordx4 v[60:63], v1, s[28:31], s50 offen offset:3072 nt
  v_dot2c_f32_bf16_dpp v8, v21, v40 row_newbcast:8 row_mask:0xf bank_mask:0xf
  v_dot2c_f32_bf16_dpp v9, v22, v40 row_newbcast:8 row_mask:0xf bank_mask:0xf
  v_dot2c_f32_bf16_dpp v10, v21, v41 row_newbcast:8 row_mask:0xf bank_mask:0xf
  v_dot2c_f32_bf16_dpp v11, v22, v41 row_newbcast:8 row_mask:0xf bank_mask:0xf
  v_dot2c_f32_bf16_dpp v12, v21, v42 row_newbcast:8 row_mask:0xf bank_mask:0xf
  v_dot2c_f32_bf16_dpp v13, v22, v42 row_newbcast:8 row_mask:0xf bank_mask:0xf
  v_dot2c_f32_bf16_dpp v14, v21, v43 row_newbcast:8 row_mask:0xf bank_mask:0xf
  v_dot2c_f32_bf16_dpp v15, v22, v43 row_newbcast:8 row_mask:0xf bank_mask:0xf
  s_cmp_lt_u32 s51, 7733248
  s_cbranch_scc1 L_vloop
  s_waitcnt vmcnt(4)
  s_waitcnt lgkmcnt(0)
  s_add_u32 s50, s49, 1920
  s_lshl_b32 s50, s50, 12
  s_mov_b32 s49, 1
  s_atomic_add s49, s[40:41], 0 glc
  buffer_load_dwordx4 v[32:35], v1, s[24:27], s50 offen offset:0 nt
  v_dot2c_f32_bf16_dpp v8, v21, v44 row_newbcast:12 row_mask:0xf bank_mask:0xf
  v_dot2c_f32_bf16_dpp v9, v22, v44 row_newbcast:12 row_mask:0xf bank_mask:0xf
  v_dot2c_f32_bf16_dpp v10, v21, v45 row_newbcast:12 row_mask:0xf bank_mask:0xf
  v_dot2c_f32_bf16_dpp v11, v22, v45 row_newbcast:12 row_mask:0xf bank_mask:0xf
  v_dot2c_f32_bf16_dpp v12, v21, v46 row_newbcast:12 row_mask:0xf bank_mask:0xf
  v_dot2c_f32_bf16_dpp v13, v22, v46 row_newbcast:12 row_mask:0xf bank_mask:0xf
  v_dot2c_f32_bf16_dpp v14, v21, v47 row_newbcast:12 row_mask:0xf bank_mask:0xf
  v_dot2c_f32_bf16_dpp v15, v22, v47 row_newbcast:12 row_mask:0xf bank_mask:0xf
  s_waitcnt vmcnt(4)
  buffer_load_dwordx4 v[36:39], v1, s[24:27], s50 offen offset:1024 nt
  v_sub_f32 v20, v30, v6
  v_mul_f32 v20, s62, v20
  v_exp_f32 v20, v20
  s_nop 0
  v_cvt_pk_bf16_f32 v21, v20, 0
  v_cvt_pk_bf16_f32 v22, 0, v20
  v_add_f32 v7, v7, v20
  v_dot2c_f32_bf16_dpp v8, v21, v48 row_newbcast:0 row_mask:0xf bank_mask:0xf
  v_dot2c_f32_bf16_dpp v9, v22, v48 row_newbcast:0 row_mask:0xf bank_mask:0xf
  v_dot2c_f32_bf16_dpp v10, v21, v49 row_newbcast:0 row_mask:0xf bank_mask:0xf
  v_dot2c_f32_bf16_dpp v11, v22, v49 row_newbcast:0 row_mask:0xf bank_mask:0xf
  v_dot2c_f32_bf16_dpp v12, v21, v50 row_newbcast:0 row_mask:0xf bank_mask:0xf
  v_dot2c_f32_bf16_dpp v13, v22, v50 row_newbcast:0 row_mask:0xf bank_mask:0xf
  v_dot2c_f32_bf16_dpp v14, v21, v51 row_newbcast:0 row_mask:0xf bank_mask:0xf
  v_dot2c_f32_bf16_dpp v15, v22, v51 row_newbcast:0 row_mask:0xf bank_mask:0xf
  s_waitcnt vmcnt(4)
  buffer_load_dwordx4 v[40:43], v1, s[24:27], s50 offen offset:2048 nt
  v_dot2c_f32_bf16_dpp v8, v21, v52 row_newbcast:4 row_mask:0xf bank_mask:0xf
  v_dot2c_f32_bf16_dpp v9, v22, v52 row_newbcast:4 row_mask:0xf bank_mask:0xf
  v_dot2c_f32_bf16_dpp v10, v21, v53 row_newbcast:4 row_mask:0xf bank_mask:0xf
  v_dot2c_f32_bf16_dpp v11, v22, v53 row_newbcast:4 row_mask:0xf bank_mask:0xf
  v_dot2c_f32_bf16_dpp v12, v21, v54 row_newbcast:4 row_mask:0xf bank_mask:0xf
  v_dot2c_f32_bf16_dpp v13, v22, v54 row_newbcast:4 row_mask:0xf bank_mask:0xf
  v_dot2c_f32_bf16_dpp v14, v21, v55 row_newbcast:4 row_mask:0xf bank_mask:0xf
  v_dot2c_f32_bf16_dpp v15, v22, v55 row_newbcast:4 row_mask:0xf bank_mask:0xf
  s_waitcnt vmcnt(4)
  buffer_load_dwordx4 v[44:47], v1, s[24:27], s50 offen offset:3072 nt
  v_dot2c_f32_bf16_dpp v8, v21, v56 row_newbcast:8 row_mask:0xf bank_mask:0xf
  v_dot2c_f32_bf16_dpp v9, v22, v56 row_newbcast:8 row_mask:0xf bank_mask:0xf
  v_dot2c_f32_bf16_dpp v10, v21, v57 row_newbcast:8 row_mask:0xf bank_mask:0xf
  v_dot2c_f32_bf16_dpp v11, v22, v57 row_newbcast:8 row_mask:0xf bank_mask:0xf
  v_dot2c_f32_bf16_dpp v12, v21, v58 row_newbcast:8 row_mask:0xf bank_mask:0xf
  v_dot2c_f32_bf16_dpp v13, v22, v58 row_newbcast:8 row_mask:0xf bank_mask:0xf
  v_dot2c_f32_bf16_dpp v14, v21, v59 row_newbcast:8 row_mask:0xf bank_mask:0xf
  v_dot2c_f32_bf16_dpp v15, v22, v59 row_newbcast:8 row_mask:0xf bank_mask:0xf
  s_waitcnt vmcnt(4)
  buffer_load_dwordx4 v[48:51], v1, s[28:31], s50 offen offset:0 nt
  v_dot2c_f32_bf16_dpp v8, v21, v60 row_newbcast:12 row_mask:0xf bank_mask:0xf
  v_dot2c_f32_bf16_dpp v9, v22, v60 row_newbcast:12 row_mask:0xf bank_mask:0xf
  v_dot2c_f32_bf16_dpp v10, v21, v61 row_newbcast:12 row_mask:0xf bank_mask:0xf
  v_dot2c_f32_bf16_dpp v11, v22, v61 row_newbcast:12 row_mask:0xf bank_mask:0xf
  v_dot2c_f32_bf16_dpp v12, v21, v62 row_newbcast:12 row_mask:0xf bank_mask:0xf
  v_dot2c_f32_bf16_dpp v13, v22, v62 row_newbcast:12 row_mask:0xf bank_mask:0xf
  v_dot2c_f32_bf16_dpp v14, v21, v63 row_newbcast:12 row_mask:0xf bank_mask:0xf
  v_dot2c_f32_bf16_dpp v15, v22, v63 row_newbcast:12 row_mask:0xf bank_mask:0xf
  s_cmp_lt_u32 s50, 0x800000
  s_cbranch_scc1 L_entry
  v_lshlrev_b32 v24, 2, v0
  buffer_load_dword v96, v24, s[36:39], s56 offen offset:0 nt
  buffer_load_dword v97, v24, s[36:39], s56 offen offset:1280 nt
  buffer_load_dword v98, v24, s[36:39], s56 offen offset:2560 nt
  s_add_u32 s56, s56, 3840
  buffer_load_dword v99, v24, s[36:39], s56 offen offset:0 nt
  buffer_load_dword v100, v24, s[36:39], s56 offen offset:1280 nt
  buffer_load_dword v101, v24, s[36:39], s56 offen offset:2560 nt
  s_add_u32 s56, s56, 3840
  buffer_load_dword v102, v24, s[36:39], s56 offen offset:0 nt
  buffer_load_dword v103, v24, s[36:39], s56 offen offset:1280 nt
  buffer_load_dword v104, v24, s[36:39], s56 offen offset:2560 nt
  s_add_u32 s56, s56, 3840
  buffer_load_dword v105, v24, s[36:39], s56 offen offset:0 nt
  buffer_load_dword v106, v24, s[36:39], s56 offen offset:1280 nt
  buffer_load_dword v107, v24, s[36:39], s56 offen offset:2560 nt
  s_add_u32 s56, s56, 3840
  buffer_load_dword v108, v24, s[36:39], s56 offen offset:0 nt
  buffer_load_dword v109, v24, s[36:39], s56 offen offset:1280 nt
  buffer_load_dword v110, v24, s[36:39], s56 offen offset:2560 nt
  s_add_u32 s56, s56, 3840
  buffer_load_dword v111, v24, s[36:39], s56 offen offset:0 nt
  s_branch L_done
L_loop:
  s_waitcnt vmcnt(4)
  s_waitcnt lgkmcnt(0)
  s_cmp_ge_u32 s49, 128
  s_cbranch_scc1 L_drain
  s_add_u32 s50, s49, 1920
  s_lshl_b32 s50, s50, 12
  s_mov_b32 s49, 1
  s_atomic_add s49, s[40:41], 0 glc
  buffer_load_dwordx4 v[32:35], v1, s[24:27], s50 offen offset:0 nt
  v_mov_b32 v19, 0
  v_dot2c_f32_bf16 v19, v44, v2
  v_dot2c_f32_bf16 v19, v45, v3
  v_dot2c_f32_bf16 v19, v46, v4
  v_dot2c_f32_bf16 v19, v47, v5
  v_add_f32_dpp v16, v16, v16 row_ror:8 row_mask:0xf bank_mask:0x3
  v_add_f32_dpp v17, v17, v17 row_ror:8 row_mask:0xf bank_mask:0x3
  v_add_f32_dpp v16, v18, v18 row_ror:8 row_mask:0xf bank_mask:0xc
  v_add_f32_dpp v17, v19, v19 row_ror:8 row_mask:0xf bank_mask:0xc
  s_nop 0
  v_add_f32_dpp v16, v16, v16 row_half_mirror row_mask:0xf bank_mask:0x5
  v_add_f32_dpp v16, v17, v17 row_half_mirror row_mask:0xf bank_mask:0xa
  s_nop 1
  v_add_f32_dpp v16, v16, v16 quad_perm:[1,0,3,2] row_mask:0xf bank_mask:0xf
  s_nop 1
  v_add_f32_dpp v16, v16, v16 quad_perm:[2,3,0,1] row_mask:0xf bank_mask:0xf
  s_nop 1
  v_max_f32_dpp v25, v16, v16 row_ror:8 row_mask:0xf bank_mask:0xf
  s_nop 1
  v_max_f32_dpp v25, v25, v25 row_ror:4 row_mask:0xf bank_mask:0xf
  v_max_f32 v25, v25, v6
  v_sub_f32 v20, v16, v25
  v_sub_f32 v23, v6, v25
  v_mul_f32 v20, s62, v20
  v_mul_f32 v23, s62, v23
  v_exp_f32 v20, v20
  v_exp_f32 v23, v23
  v_mov_b32 v6, v25
  v_cvt_pk_bf16_f32 v21, v20, 0
  v_cvt_pk_bf16_f32 v22, 0, v20
  v_fma_f32 v7, v7, v23, v20
  v_mul_f32 v8, v8, v23
  v_mul_f32 v9, v9, v23
  v_mul_f32 v10, v10, v23
  v_mul_f32 v11, v11, v23
  v_mul_f32 v12, v12, v23
  v_mul_f32 v13, v13, v23
  v_mul_f32 v14, v14, v23
  v_mul_f32 v15, v15, v23
  s_waitcnt vmcnt(4)
  buffer_load_dwordx4 v[36:39], v1, s[24:27], s50 offen offset:1024 nt
  v_dot2c_f32_bf16_dpp v8, v21, v48 row_newbcast:0 row_mask:0xf bank_mask:0xf
  v_dot2c_f32_bf16_dpp v9, v22, v48 row_newbcast:0 row_mask:0xf bank_mask:0xf
  v_dot2c_f32_bf16_dpp v10, v21, v49 row_newbcast:0 row_mask:0xf bank_mask:0xf
  v_dot2c_f32_bf16_dpp v11, v22, v49 row_newbcast:0 row_mask:0xf bank_mask:0xf
  v_dot2c_f32_bf16_dpp v12, v21, v50 row_newbcast:0 row_mask:0xf bank_mask:0xf
  v_dot2c_f32_bf16_dpp v13, v22, v50 row_newbcast:0 row_mask:0xf bank_mask:0xf
  v_dot2c_f32_bf16_dpp v14, v21, v51 row_newbcast:0 row_mask:0xf bank_mask:0xf
  v_dot2c_f32_bf16_dpp v15, v22, v51 row_newbcast:0 row_mask:0xf bank_mask:0xf
  s_waitcnt vmcnt(4)
  buffer_load_dwordx4 v[40:43], v1, s[24:27], s50 offen offset:2048 nt
  v_dot2c_f32_bf16_dpp v8, v21, v52 row_newbcast:4 row_mask:0xf bank_mask:0xf
  v_dot2c_f32_bf16_dpp v9, v22, v52 row_newbcast:4 row_mask:0xf bank_mask:0xf
  v_dot2c_f32_bf16_dpp v10, v21, v53 row_newbcast:4 row_mask:0xf bank_mask:0xf
  v_dot2c_f32_bf16_dpp v11, v22, v53 row_newbcast:4 row_mask:0xf bank_mask:0xf
  v_dot2c_f32_bf16_dpp v12, v21, v54 row_newbcast:4 row_mask:0xf bank_mask:0xf
  v_dot2c_f32_bf16_dpp v13, v22, v54 row_newbcast:4 row_mask:0xf bank_mask:0xf
  v_dot2c_f32_bf16_dpp v14, v21, v55 row_newbcast:4 row_mask:0xf bank_mask:0xf
  v_dot2c_f32_bf16_dpp v15, v22, v55 row_newbcast:4 row_mask:0xf bank_mask:0xf
  s_waitcnt vmcnt(4)
  buffer_load_dwordx4 v[44:47], v1, s[24:27], s50 offen offset:3072 nt
  v_dot2c_f32_bf16_dpp v8, v21, v56 row_newbcast:8 row_mask:0xf bank_mask:0xf
  v_dot2c_f32_bf16_dpp v9, v22, v56 row_newbcast:8 row_mask:0xf bank_mask:0xf
  v_dot2c_f32_bf16_dpp v10, v21, v57 row_newbcast:8 row_mask:0xf bank_mask:0xf
  v_dot2c_f32_bf16_dpp v11, v22, v57 row_newbcast:8 row_mask:0xf bank_mask:0xf
  v_dot2c_f32_bf16_dpp v12, v21, v58 row_newbcast:8 row_mask:0xf bank_mask:0xf
  v_dot2c_f32_bf16_dpp v13, v22, v58 row_newbcast:8 row_mask:0xf bank_mask:0xf
  v_dot2c_f32_bf16_dpp v14, v21, v59 row_newbcast:8 row_mask:0xf bank_mask:0xf
  v_dot2c_f32_bf16_dpp v15, v22, v59 row_newbcast:8 row_mask:0xf bank_mask:0xf
  s_waitcnt vmcnt(4)
  buffer_load_dwordx4 v[48:51], v1, s[28:31], s50 offen offset:0 nt
  v_dot2c_f32_bf16_dpp v8, v21, v60 row_newbcast:12 row_mask:0xf bank_mask:0xf
  v_dot2c_f32_bf16_dpp v9, v22, v60 row_newbcast:12 row_mask:0xf bank_mask:0xf
  v_dot2c_f32_bf16_dpp v10, v21, v61 row_newbcast:12 row_mask:0xf bank_mask:0xf
  v_dot2c_f32_bf16_dpp v11, v22, v61 row_newbcast:12 row_mask:0xf bank_mask:0xf
  v_dot2c_f32_bf16_dpp v12, v21, v62 row_newbcast:12 row_mask:0xf bank_mask:0xf
  v_dot2c_f32_bf16_dpp v13, v22, v62 row_newbcast:12 row_mask:0xf bank_mask:0xf
  v_dot2c_f32_bf16_dpp v14, v21, v63 row_newbcast:12 row_mask:0xf bank_mask:0xf
  v_dot2c_f32_bf16_dpp v15, v22, v63 row_newbcast:12 row_mask:0xf bank_mask:0xf
L_entry:
  s_waitcnt vmcnt(4)
  buffer_load_dwordx4 v[52:55], v1, s[28:31], s50 offen offset:1024 nt
  v_mov_b32 v16, 0
  v_dot2c_f32_bf16 v16, v32, v2
  v_dot2c_f32_bf16 v16, v33, v3
  v_dot2c_f32_bf16 v16, v34, v4
  v_dot2c_f32_bf16 v16, v35, v5
  s_waitcnt vmcnt(4)
  buffer_load_dwordx4 v[56:59], v1, s[28:31], s50 offen offset:2048 nt
  v_mov_b32 v17, 0
  v_dot2c_f32_bf16 v17, v36, v2
  v_dot2c_f32_bf16 v17, v37, v3
  v_dot2c_f32_bf16 v17, v38, v4
  v_dot2c_f32_bf16 v17, v39, v5
  s_waitcnt vmcnt(4)
  buffer_load_dwordx4 v[60:63], v1, s[28:31], s50 offen offset:3072 nt
  v_mov_b32 v18, 0
  v_dot2c_f32_bf16 v18, v40, v2
  v_dot2c_f32_bf16 v18, v41, v3
  v_dot2c_f32_bf16 v18, v42, v4
  v_dot2c_f32_bf16 v18, v43, v5
  s_branch L_loop
L_drain:
  v_lshlrev_b32 v24, 2, v0
  buffer_load_dword v96, v24, s[36:39], s56 offen offset:0 nt
  buffer_load_dword v97, v24, s[36:39], s56 offen offset:1280 nt
  buffer_load_dword v98, v24, s[36:39], s56 offen offset:2560 nt
  s_add_u32 s56, s56, 3840
  buffer_load_dword v99, v24, s[36:39], s56 offen offset:0 nt
  buffer_load_dword v100, v24, s[36:39], s56 offen offset:1280 nt
  buffer_load_dword v101, v24, s[36:39], s56 offen offset:2560 nt
  s_add_u32 s56, s56, 3840
  buffer_load_dword v102, v24, s[36:39], s56 offen offset:0 nt
  buffer_load_dword v103, v24, s[36:39], s56 offen offset:1280 nt
  buffer_load_dword v104, v24, s[36:39], s56 offen offset:2560 nt
  s_add_u32 s56, s56, 3840
  buffer_load_dword v105, v24, s[36:39], s56 offen offset:0 nt
  buffer_load_dword v106, v24, s[36:39], s56 offen offset:1280 nt
  buffer_load_dword v107, v24, s[36:39], s56 offen offset:2560 nt
  s_add_u32 s56, s56, 3840
  buffer_load_dword v108, v24, s[36:39], s56 offen offset:0 nt
  buffer_load_dword v109, v24, s[36:39], s56 offen offset:1280 nt
  buffer_load_dword v110, v24, s[36:39], s56 offen offset:2560 nt
  s_add_u32 s56, s56, 3840
  buffer_load_dword v111, v24, s[36:39], s56 offen offset:0 nt
  s_waitcnt vmcnt(20)
  v_mov_b32 v19, 0
  v_dot2c_f32_bf16 v19, v44, v2
  v_dot2c_f32_bf16 v19, v45, v3
  v_dot2c_f32_bf16 v19, v46, v4
  v_dot2c_f32_bf16 v19, v47, v5
  v_add_f32_dpp v16, v16, v16 row_ror:8 row_mask:0xf bank_mask:0x3
  v_add_f32_dpp v17, v17, v17 row_ror:8 row_mask:0xf bank_mask:0x3
  v_add_f32_dpp v16, v18, v18 row_ror:8 row_mask:0xf bank_mask:0xc
  v_add_f32_dpp v17, v19, v19 row_ror:8 row_mask:0xf bank_mask:0xc
  s_nop 0
  v_add_f32_dpp v16, v16, v16 row_half_mirror row_mask:0xf bank_mask:0x5
  v_add_f32_dpp v16, v17, v17 row_half_mirror row_mask:0xf bank_mask:0xa
  s_nop 1
  v_add_f32_dpp v16, v16, v16 quad_perm:[1,0,3,2] row_mask:0xf bank_mask:0xf
  s_nop 1
  v_add_f32_dpp v16, v16, v16 quad_perm:[2,3,0,1] row_mask:0xf bank_mask:0xf
  s_nop 1
  v_max_f32_dpp v25, v16, v16 row_ror:8 row_mask:0xf bank_mask:0xf
  s_nop 1
  v_max_f32_dpp v25, v25, v25 row_ror:4 row_mask:0xf bank_mask:0xf
  v_max_f32 v25, v25, v6
  v_sub_f32 v20, v16, v25
  v_sub_f32 v23, v6, v25
  v_mul_f32 v20, s62, v20
  v_mul_f32 v23, s62, v23
  v_exp_f32 v20, v20
  v_exp_f32 v23, v23
  v_mov_b32 v6, v25
  v_cvt_pk_bf16_f32 v21, v20, 0
  v_cvt_pk_bf16_f32 v22, 0, v20
  v_fma_f32 v7, v7, v23, v20
  v_mul_f32 v8, v8, v23
  v_mul_f32 v9, v9, v23
  v_mul_f32 v10, v10, v23
  v_mul_f32 v11, v11, v23
  v_mul_f32 v12, v12, v23
  v_mul_f32 v13, v13, v23
  v_mul_f32 v14, v14, v23
  v_mul_f32 v15, v15, v23
  s_waitcnt vmcnt(19)
  v_dot2c_f32_bf16_dpp v8, v21, v48 row_newbcast:0 row_mask:0xf bank_mask:0xf
  v_dot2c_f32_bf16_dpp v9, v22, v48 row_newbcast:0 row_mask:0xf bank_mask:0xf
  v_dot2c_f32_bf16_dpp v10, v21, v49 row_newbcast:0 row_mask:0xf bank_mask:0xf
  v_dot2c_f32_bf16_dpp v11, v22, v49 row_newbcast:0 row_mask:0xf bank_mask:0xf
  v_dot2c_f32_bf16_dpp v12, v21, v50 row_newbcast:0 row_mask:0xf bank_mask:0xf
  v_dot2c_f32_bf16_dpp v13, v22, v50 row_newbcast:0 row_mask:0xf bank_mask:0xf
  v_dot2c_f32_bf16_dpp v14, v21, v51 row_newbcast:0 row_mask:0xf bank_mask:0xf
  v_dot2c_f32_bf16_dpp v15, v22, v51 row_newbcast:0 row_mask:0xf bank_mask:0xf
  s_waitcnt vmcnt(18)
  v_dot2c_f32_bf16_dpp v8, v21, v52 row_newbcast:4 row_mask:0xf bank_mask:0xf
  v_dot2c_f32_bf16_dpp v9, v22, v52 row_newbcast:4 row_mask:0xf bank_mask:0xf
  v_dot2c_f32_bf16_dpp v10, v21, v53 row_newbcast:4 row_mask:0xf bank_mask:0xf
  v_dot2c_f32_bf16_dpp v11, v22, v53 row_newbcast:4 row_mask:0xf bank_mask:0xf
  v_dot2c_f32_bf16_dpp v12, v21, v54 row_newbcast:4 row_mask:0xf bank_mask:0xf
  v_dot2c_f32_bf16_dpp v13, v22, v54 row_newbcast:4 row_mask:0xf bank_mask:0xf
  v_dot2c_f32_bf16_dpp v14, v21, v55 row_newbcast:4 row_mask:0xf bank_mask:0xf
  v_dot2c_f32_bf16_dpp v15, v22, v55 row_newbcast:4 row_mask:0xf bank_mask:0xf
  s_waitcnt vmcnt(17)
  v_dot2c_f32_bf16_dpp v8, v21, v56 row_newbcast:8 row_mask:0xf bank_mask:0xf
  v_dot2c_f32_bf16_dpp v9, v22, v56 row_newbcast:8 row_mask:0xf bank_mask:0xf
  v_dot2c_f32_bf16_dpp v10, v21, v57 row_newbcast:8 row_mask:0xf bank_mask:0xf
  v_dot2c_f32_bf16_dpp v11, v22, v57 row_newbcast:8 row_mask:0xf bank_mask:0xf
  v_dot2c_f32_bf16_dpp v12, v21, v58 row_newbcast:8 row_mask:0xf bank_mask:0xf
  v_dot2c_f32_bf16_dpp v13, v22, v58 row_newbcast:8 row_mask:0xf bank_mask:0xf
  v_dot2c_f32_bf16_dpp v14, v21, v59 row_newbcast:8 row_mask:0xf bank_mask:0xf
  v_dot2c_f32_bf16_dpp v15, v22, v59 row_newbcast:8 row_mask:0xf bank_mask:0xf
  s_waitcnt vmcnt(16)
  v_dot2c_f32_bf16_dpp v8, v21, v60 row_newbcast:12 row_mask:0xf bank_mask:0xf
  v_dot2c_f32_bf16_dpp v9, v22, v60 row_newbcast:12 row_mask:0xf bank_mask:0xf
  v_dot2c_f32_bf16_dpp v10, v21, v61 row_newbcast:12 row_mask:0xf bank_mask:0xf
  v_dot2c_f32_bf16_dpp v11, v22, v61 row_newbcast:12 row_mask:0xf bank_mask:0xf
  v_dot2c_f32_bf16_dpp v12, v21, v62 row_newbcast:12 row_mask:0xf bank_mask:0xf
  v_dot2c_f32_bf16_dpp v13, v22, v62 row_newbcast:12 row_mask:0xf bank_mask:0xf
  v_dot2c_f32_bf16_dpp v14, v21, v63 row_newbcast:12 row_mask:0xf bank_mask:0xf
  v_dot2c_f32_bf16_dpp v15, v22, v63 row_newbcast:12 row_mask:0xf bank_mask:0xf
L_done:
  v_add_f32_dpp v7, v7, v7 row_ror:8 row_mask:0xf bank_mask:0xf
  v_lshrrev_b32 v26, 4, v0
  s_nop 0
  v_add_f32_dpp v7, v7, v7 row_ror:4 row_mask:0xf bank_mask:0xf
  s_lshl_b32 s42, s22, 2
  v_add_u32 v26, s42, v26
  v_lshlrev_b32 v27, 3, v26
  s_lshl_b32 s42, s22, 11
  v_lshlrev_b32 v26, 5, v0
  v_add_u32 v26, s42, v26
  ds_write_b128 v26, v[8:11] offset:768
  ds_write_b128 v26, v[12:15] offset:784
  ds_write_b64 v27, v[6:7] offset:256
  s_waitcnt lgkmcnt(0)
  s_barrier
  s_lshl_b32 s44, s22, 3
  v_lshrrev_b32 v65, 3, v0
  v_and_b32 v68, 7, v0
  v_add_u32 v65, s44, v65
  v_mul_u32_u24 v65, 32768, v65
  v_lshl_add_u32 v65, v68, 4, v65
  s_mul_i32 s54, s20, 8
  s_add_u32 s54, s54, s3
  s_lshl_b32 s54, s54, 7
  s_add_u32 s54, s54, 1048576
  v_mov_b32 v68, 0
  v_mov_b32 v69, s60
  v_mov_b32 v70, 0
  v_mov_b32 v71, s61
  v_mov_b32 v67, 0
  s_waitcnt vmcnt(0)
  s_mov_b32 s42, 0x05040100
  s_mov_b32 s43, 0x07060302
  v_perm_b32 v14, v97, v96, s42
  v_perm_b32 v97, v97, v96, s43
  v_mov_b32 v96, v14
  v_perm_b32 v15, v99, v98, s42
  v_perm_b32 v99, v99, v98, s43
  v_mov_b32 v98, v15
  v_perm_b32 v14, v101, v100, s42
  v_perm_b32 v101, v101, v100, s43
  v_mov_b32 v100, v14
  v_perm_b32 v15, v103, v102, s42
  v_perm_b32 v103, v103, v102, s43
  v_mov_b32 v102, v15
  v_perm_b32 v14, v105, v104, s42
  v_perm_b32 v105, v105, v104, s43
  v_mov_b32 v104, v14
  v_perm_b32 v15, v107, v106, s42
  v_perm_b32 v107, v107, v106, s43
  v_mov_b32 v106, v15
  v_perm_b32 v14, v109, v108, s42
  v_perm_b32 v109, v109, v108, s43
  v_mov_b32 v108, v14
  v_perm_b32 v15, v111, v110, s42
  v_perm_b32 v111, v111, v110, s43
  v_mov_b32 v110, v15
  s_barrier
  ds_read_b128 v[40:43], v67 offset:512
  ds_read_b128 v[44:47], v67 offset:528
  s_waitcnt lgkmcnt(1)
  v_dot2c_f32_bf16 v68, v40, v96
  v_dot2c_f32_bf16 v70, v40, v97
  v_dot2c_f32_bf16 v68, v41, v98
  v_dot2c_f32_bf16 v70, v41, v99
  v_dot2c_f32_bf16 v68, v42, v100
  v_dot2c_f32_bf16 v70, v42, v101
  v_dot2c_f32_bf16 v68, v43, v102
  v_dot2c_f32_bf16 v70, v43, v103
  s_waitcnt lgkmcnt(0)
  v_dot2c_f32_bf16 v68, v44, v104
  v_dot2c_f32_bf16 v70, v44, v105
  v_dot2c_f32_bf16 v68, v45, v106
  v_dot2c_f32_bf16 v70, v45, v107
  v_dot2c_f32_bf16 v68, v46, v108
  v_dot2c_f32_bf16 v70, v46, v109
  v_dot2c_f32_bf16 v68, v47, v110
  v_dot2c_f32_bf16 v70, v47, v111
  s_nop 2
  buffer_store_dwordx4 v[68:71], v65, s[32:35], s54 offen sc1
L_scons:
  s_cmp_ge_u32 s57, 40
  s_cbranch_scc1 L_fin
  v_lshlrev_b32 v4, 4, v0
  s_mul_i32 s45, s57, 32768
  s_mul_i32 s43, s22, 8192
  s_add_u32 s45, s45, s43
  s_add_u32 s45, s45, 1048576
  s_add_u32 s53, s45, 4096
  v_and_b32 v5, 7, v0
  v_lshrrev_b32 v6, 5, v0
  v_lshl_add_u32 v5, v5, 1, v6
  v_lshlrev_b32 v5, 2, v5
  s_lshl_b32 s43, s22, 6
  v_add_u32 v5, s43, v5
  s_lshl_b32 s44, s22, 10
  s_add_u32 s44, s44, 98304
  s_mov_b32 s46, 0xff
  s_mov_b32 s47, 0xff
  s_waitcnt vmcnt(0)
L_dn:
  buffer_load_dwordx4 v[8:11], v4, s[32:35], s44 offen sc1
  s_waitcnt vmcnt(0)
  v_xor_b32 v7, s60, v9
  v_bitop3_b32 v7, v11, s61, v7 bitop3:0xbe
  v_cmp_ne_u32 vcc, 0, v7
  s_cbranch_vccz L_dn_ok
  s_sleep 2
  s_sub_u32 s59, s59, 1
  s_cmp_gt_i32 s59, 0
  s_cbranch_scc1 L_dn
L_dn_ok:
  s_mov_b64 s[64:65], -1
  s_mov_b64 s[66:67], -1
  s_mov_b64 s[68:69], -1
  s_mov_b64 s[70:71], -1
  s_mov_b64 s[72:73], -1
  s_mov_b64 s[74:75], -1
  s_mov_b64 s[76:77], -1
  s_mov_b64 s[78:79], -1
  v_mov_b32 v8, 0
  v_mov_b32 v9, 0
L_f:
  s_mov_b64 exec, s[64:65]
  s_cbranch_execz L_fs0
  buffer_load_dwordx4 v[32:35], v4, s[32:35], s45 offen offset:0 sc1
L_fs0:
  s_mov_b64 exec, s[66:67]
  s_cbranch_execz L_fs1
  buffer_load_dwordx4 v[36:39], v4, s[32:35], s45 offen offset:1024 sc1
L_fs1:
  s_mov_b64 exec, s[68:69]
  s_cbranch_execz L_fs2
  buffer_load_dwordx4 v[40:43], v4, s[32:35], s45 offen offset:2048 sc1
L_fs2:
  s_mov_b64 exec, s[70:71]
  s_cbranch_execz L_fs3
  buffer_load_dwordx4 v[44:47], v4, s[32:35], s45 offen offset:3072 sc1
L_fs3:
  s_mov_b64 exec, s[72:73]
  s_cbranch_execz L_fs4
  buffer_load_dwordx4 v[48:51], v4, s[32:35], s53 offen offset:0 sc1
L_fs4:
  s_mov_b64 exec, s[74:75]
  s_cbranch_execz L_fs5
  buffer_load_dwordx4 v[52:55], v4, s[32:35], s53 offen offset:1024 sc1
L_fs5:
  s_mov_b64 exec, s[76:77]
  s_cbranch_execz L_fs6
  buffer_load_dwordx4 v[56:59], v4, s[32:35], s53 offen offset:2048 sc1
L_fs6:
  s_mov_b64 exec, s[78:79]
  s_cbranch_execz L_fs7
  buffer_load_dwordx4 v[60:63], v4, s[32:35], s53 offen offset:3072 sc1
L_fs7:
  s_mov_b64 exec, -1
  s_waitcnt vmcnt(0)
  v_xor_b32 v12, s60, v33
  v_xor_b32 v13, s60, v37
  v_xor_b32 v14, s60, v41
  v_xor_b32 v15, s60, v45
  v_xor_b32 v16, s60, v49
  v_xor_b32 v17, s60, v53
  v_xor_b32 v18, s60, v57
  v_xor_b32 v19, s60, v61
  v_bitop3_b32 v12, v35, s61, v12 bitop3:0xbe
  v_bitop3_b32 v13, v39, s61, v13 bitop3:0xbe
  v_bitop3_b32 v14, v43, s61, v14 bitop3:0xbe
  v_bitop3_b32 v15, v47, s61, v15 bitop3:0xbe
  v_bitop3_b32 v16, v51, s61, v16 bitop3:0xbe
  v_bitop3_b32 v17, v55, s61, v17 bitop3:0xbe
  v_bitop3_b32 v18, v59, s61, v18 bitop3:0xbe
  v_bitop3_b32 v19, v63, s61, v19 bitop3:0xbe
  v_cmp_ne_u32 s[64:65], 0, v12
  v_cmp_ne_u32 s[66:67], 0, v13
  v_cmp_ne_u32 s[68:69], 0, v14
  v_cmp_ne_u32 s[70:71], 0, v15
  v_cmp_ne_u32 s[72:73], 0, v16
  v_cmp_ne_u32 s[74:75], 0, v17
  v_cmp_ne_u32 s[76:77], 0, v18
  v_cmp_ne_u32 s[78:79], 0, v19
  v_add_f32 v8, v32, v36
  v_add_f32 v9, v34, v38
  v_add_f32 v8, v8, v40
  v_add_f32 v9, v9, v42
  v_add_f32 v8, v8, v44
  v_add_f32 v9, v9, v46
  v_add_f32 v8, v8, v48
  v_add_f32 v9, v9, v50
  v_add_f32 v8, v8, v52
  v_add_f32 v9, v9, v54
  v_add_f32 v8, v8, v56
  v_add_f32 v9, v9, v58
  v_add_f32 v8, v8, v60
  v_add_f32 v9, v9, v62
  s_or_b64 s[42:43], s[64:65], s[66:67]
  s_or_b64 s[42:43], s[42:43], s[68:69]
  s_or_b64 s[42:43], s[42:43], s[70:71]
  s_or_b64 s[42:43], s[42:43], s[72:73]
  s_or_b64 s[42:43], s[42:43], s[74:75]
  s_or_b64 s[42:43], s[42:43], s[76:77]
  s_or_b64 s[42:43], s[42:43], s[78:79]
  s_cbranch_scc0 L_f_ok
  s_sub_u32 s59, s59, 1
  s_cmp_gt_i32 s59, 0
  s_cbranch_scc1 L_f
L_f_ok:
  v_permlane32_swap_b32 v8, v9
  v_add_f32 v8, v8, v9
  v_mov_b32 v9, v8
  s_nop 1
  v_permlane16_swap_b32 v8, v9
  v_add_f32 v8, v8, v9
  s_nop 1
  v_add_f32_dpp v8, v8, v8 row_ror:8 row_mask:0xf bank_mask:0xf
  s_mov_b64 exec, s[46:47]
  ds_write_b32 v5, v8 offset:0
  s_waitcnt lgkmcnt(0)
  s_barrier
  s_branch L_fin
L_helper:
  s_setprio 3
  s_mov_b32 s22, 4
  v_lshrrev_b32 v2, 4, v0
  v_and_b32 v3, 7, v0
  v_lshrrev_b32 v4, 3, v0
  s_lshr_b32 s42, s21, 1
  s_mul_i32 s42, s42, 160
  v_mul_u32_u24 v4, 20, v4
  v_add_u32 v4, s42, v4
  v_lshlrev_b32 v5, 1, v4
  v_lshlrev_b32 v4, 13, v4
  s_lshl_b32 s42, s20, 8
  s_and_b32 s43, s21, 1
  s_lshl_b32 s43, s43, 7
  s_add_u32 s42, s42, s43
  v_lshl_add_u32 v4, v3, 4, v4
  v_add_u32 v4, s42, v4
  v_mov_b32 v28, 0
  ds_write_b32 v28, v28 offset:384
  s_mov_b32 s43, 65536
  s_lshl_b32 s42, s20, 8
  s_waitcnt lgkmcnt(0)
  s_mov_b32 s32, s18
  s_mov_b32 s33, s19
  s_mov_b32 s34, 2359296
  s_mov_b32 s35, 0x20000
  s_cmp_lg_u32 s21, 0
  s_cbranch_scc1 L_nozero
  s_mov_b64 exec, 1
  buffer_store_dword v28, v28, s[32:35], s42 offen sc1
  s_mov_b64 exec, -1
L_nozero:
  buffer_load_dword v29, v28, s[32:35], s43 offen sc1
  s_mov_b32 s44, s4
  s_mov_b32 s45, s5
  s_mov_b32 s46, 1280
  s_mov_b32 s47, 0x20000
  s_mov_b32 s36, s10
  s_mov_b32 s37, s11
  s_mov_b32 s38, 5242880
  s_mov_b32 s39, 0x20000
  buffer_load_dwordx4 v[16:19], v5, s[44:47], 0 offen
  buffer_load_dwordx4 v[20:23], v5, s[44:47], 0 offen offset:16
  buffer_load_dwordx2 v[24:25], v5, s[44:47], 0 offen offset:32
  buffer_load_dwordx4 v[32:35], v4, s[36:39], 0 offen nt
  s_mov_b32 s42, 8192
  buffer_load_dwordx4 v[36:39], v4, s[36:39], s42 offen nt
  s_mov_b32 s42, 16384
  buffer_load_dwordx4 v[40:43], v4, s[36:39], s42 offen nt
  s_mov_b32 s42, 24576
  buffer_load_dwordx4 v[44:47], v4, s[36:39], s42 offen nt
  s_mov_b32 s42, 32768
  buffer_load_dwordx4 v[48:51], v4, s[36:39], s42 offen nt
  s_mov_b32 s42, 40960
  buffer_load_dwordx4 v[52:55], v4, s[36:39], s42 offen nt
  s_mov_b32 s42, 49152
  buffer_load_dwordx4 v[56:59], v4, s[36:39], s42 offen nt
  s_mov_b32 s42, 57344
  buffer_load_dwordx4 v[60:63], v4, s[36:39], s42 offen nt
  s_mov_b32 s42, 65536
  buffer_load_dwordx4 v[64:67], v4, s[36:39], s42 offen nt
  s_mov_b32 s42, 73728
  buffer_load_dwordx4 v[68:71], v4, s[36:39], s42 offen nt
  s_mov_b32 s42, 81920
  buffer_load_dwordx4 v[72:75], v4, s[36:39], s42 offen nt
  s_mov_b32 s42, 90112
  buffer_load_dwordx4 v[76:79], v4, s[36:39], s42 offen nt
  s_mov_b32 s42, 98304
  buffer_load_dwordx4 v[80:83], v4, s[36:39], s42 offen nt
  s_mov_b32 s42, 106496
  buffer_load_dwordx4 v[84:87], v4, s[36:39], s42 offen nt
  s_mov_b32 s42, 114688
  buffer_load_dwordx4 v[88:91], v4, s[36:39], s42 offen nt
  s_mov_b32 s42, 122880
  buffer_load_dwordx4 v[92:95], v4, s[36:39], s42 offen nt
  s_mov_b32 s42, 131072
  buffer_load_dwordx4 v[96:99], v4, s[36:39], s42 offen nt
  s_mov_b32 s42, 139264
  buffer_load_dwordx4 v[100:103], v4, s[36:39], s42 offen nt
  s_mov_b32 s42, 147456
  buffer_load_dwordx4 v[104:107], v4, s[36:39], s42 offen nt
  s_mov_b32 s42, 155648
  buffer_load_dwordx4 v[108:111], v4, s[36:39], s42 offen nt
  s_mov_b32 s36, s12
  s_mov_b32 s37, s13
  s_mov_b32 s39, 0x20000
  s_cmp_eq_u32 s23, 0
  s_cselect_b32 s38, 5242880, 0
  s_lshl_b32 s56, s20, 7
  s_mul_i32 s42, s3, 16
  s_add_u32 s56, s56, s42
  s_mul_i32 s56, s56, 1280
  s_lshl_b32 s42, s22, 8
  s_add_u32 s56, s56, s42
  v_lshlrev_b32 v1, 2, v0
  buffer_load_dword v128, v1, s[36:39], s56 offen offset:0 nt
  buffer_load_dword v129, v1, s[36:39], s56 offen offset:1280 nt
  buffer_load_dword v130, v1, s[36:39], s56 offen offset:2560 nt
  s_add_u32 s56, s56, 3840
  buffer_load_dword v131, v1, s[36:39], s56 offen offset:0 nt
  buffer_load_dword v132, v1, s[36:39], s56 offen offset:1280 nt
  buffer_load_dword v133, v1, s[36:39], s56 offen offset:2560 nt
  s_add_u32 s56, s56, 3840
  buffer_load_dword v134, v1, s[36:39], s56 offen offset:0 nt
  buffer_load_dword v135, v1, s[36:39], s56 offen offset:1280 nt
  buffer_load_dword v136, v1, s[36:39], s56 offen offset:2560 nt
  s_add_u32 s56, s56, 3840
  buffer_load_dword v137, v1, s[36:39], s56 offen offset:0 nt
  buffer_load_dword v138, v1, s[36:39], s56 offen offset:1280 nt
  buffer_load_dword v139, v1, s[36:39], s56 offen offset:2560 nt
  s_add_u32 s56, s56, 3840
  buffer_load_dword v140, v1, s[36:39], s56 offen offset:0 nt
  buffer_load_dword v141, v1, s[36:39], s56 offen offset:1280 nt
  buffer_load_dword v142, v1, s[36:39], s56 offen offset:2560 nt
  s_add_u32 s56, s56, 3840
  buffer_load_dword v143, v1, s[36:39], s56 offen offset:0 nt
  s_barrier
  v_and_b32 v6, 1, v3
  v_cmp_eq_u32 vcc, 1, v6
  v_mov_b32 v6, 0x0c0c0100
  v_mov_b32 v7, 0x01000c0c
  v_cndmask_b32 v6, v6, v7, vcc
  v_mov_b32 v7, 0x0c0c0302
  v_mov_b32 v26, 0x03020c0c
  v_cndmask_b32 v7, v7, v26, vcc
  v_lshrrev_b32 v26, 1, v3
  v_mov_b32 v27, 0x0c0c0c0c
  v_cmp_eq_u32 vcc, 0, v26
  s_nop 1
  v_cndmask_b32 v8, v27, v6, vcc
  v_cndmask_b32 v9, v27, v7, vcc
  v_cmp_eq_u32 vcc, 1, v26
  s_nop 1
  v_cndmask_b32 v10, v27, v6, vcc
  v_cndmask_b32 v11, v27, v7, vcc
  v_cmp_eq_u32 vcc, 2, v26
  s_nop 1
  v_cndmask_b32 v12, v27, v6, vcc
  v_cndmask_b32 v13, v27, v7, vcc
  v_cmp_eq_u32 vcc, 3, v26
  s_nop 1
  v_cndmask_b32 v14, v27, v6, vcc
  v_cndmask_b32 v15, v27, v7, vcc
  v_lshlrev_b32 v4, 6, v3
  v_and_b32 v5, 1, v2
  v_lshl_add_u32 v4, v5, 5, v4
  v_lshrrev_b32 v5, 1, v2
  v_lshl_add_u32 v4, v5, 4, v4
  s_lshl_b32 s46, s2, 9
  s_add_u32 s46, s46, 131072
  s_mov_b32 s44, 0x00ff00ff
  s_mov_b32 s45, 0x00ff00ff
  s_waitcnt vmcnt(39)
  v_readfirstlane_b32 s58, v29
  s_mul_i32 s60, s58, 0x9E3779B1
  s_add_u32 s60, s60, 0x7F4A7C15
  s_add_u32 s61, s58, 1
  s_waitcnt vmcnt(36)
  v_perm_b32 v112, v16, v16, v8
  v_perm_b32 v113, v16, v16, v10
  v_perm_b32 v114, v16, v16, v12
  v_perm_b32 v115, v16, v16, v14
  v_perm_b32 v116, v16, v16, v9
  v_perm_b32 v117, v16, v16, v11
  v_perm_b32 v118, v16, v16, v13
  v_perm_b32 v119, v16, v16, v15
  v_perm_b32 v120, v17, v17, v8
  v_perm_b32 v121, v17, v17, v10
  v_perm_b32 v122, v17, v17, v12
  v_perm_b32 v123, v17, v17, v14
  s_waitcnt vmcnt(35)
  v_mfma_f32_16x16x32_bf16 v[28:31], v[112:115], v[32:35], 0
  v_perm_b32 v124, v17, v17, v9
  v_perm_b32 v125, v17, v17, v11
  v_perm_b32 v126, v17, v17, v13
  v_perm_b32 v127, v17, v17, v15
  s_waitcnt vmcnt(34)
  v_mfma_f32_16x16x32_bf16 v[28:31], v[116:119], v[36:39], v[28:31]
  v_perm_b32 v112, v18, v18, v8
  v_perm_b32 v113, v18, v18, v10
  v_perm_b32 v114, v18, v18, v12
  v_perm_b32 v115, v18, v18, v14
  s_waitcnt vmcnt(33)
  v_mfma_f32_16x16x32_bf16 v[28:31], v[120:123], v[40:43], v[28:31]
  v_perm_b32 v116, v18, v18, v9
  v_perm_b32 v117, v18, v18, v11
  v_perm_b32 v118, v18, v18, v13
  v_perm_b32 v119, v18, v18, v15
  s_waitcnt vmcnt(32)
  v_mfma_f32_16x16x32_bf16 v[28:31], v[124:127], v[44:47], v[28:31]
  v_perm_b32 v120, v19, v19, v8
  v_perm_b32 v121, v19, v19, v10
  v_perm_b32 v122, v19, v19, v12
  v_perm_b32 v123, v19, v19, v14
  s_waitcnt vmcnt(31)
  v_mfma_f32_16x16x32_bf16 v[28:31], v[112:115], v[48:51], v[28:31]
  v_perm_b32 v124, v19, v19, v9
  v_perm_b32 v125, v19, v19, v11
  v_perm_b32 v126, v19, v19, v13
  v_perm_b32 v127, v19, v19, v15
  s_waitcnt vmcnt(30)
  v_mfma_f32_16x16x32_bf16 v[28:31], v[116:119], v[52:55], v[28:31]
  v_perm_b32 v112, v20, v20, v8
  v_perm_b32 v113, v20, v20, v10
  v_perm_b32 v114, v20, v20, v12
  v_perm_b32 v115, v20, v20, v14
  s_waitcnt vmcnt(29)
  v_mfma_f32_16x16x32_bf16 v[28:31], v[120:123], v[56:59], v[28:31]
  v_perm_b32 v116, v20, v20, v9
  v_perm_b32 v117, v20, v20, v11
  v_perm_b32 v118, v20, v20, v13
  v_perm_b32 v119, v20, v20, v15
  s_waitcnt vmcnt(28)
  v_mfma_f32_16x16x32_bf16 v[28:31], v[124:127], v[60:63], v[28:31]
  v_perm_b32 v120, v21, v21, v8
  v_perm_b32 v121, v21, v21, v10
  v_perm_b32 v122, v21, v21, v12
  v_perm_b32 v123, v21, v21, v14
  s_waitcnt vmcnt(27)
  v_mfma_f32_16x16x32_bf16 v[28:31], v[112:115], v[64:67], v[28:31]
  v_perm_b32 v124, v21, v21, v9
  v_perm_b32 v125, v21, v21, v11
  v_perm_b32 v126, v21, v21, v13
  v_perm_b32 v127, v21, v21, v15
  s_waitcnt vmcnt(26)
  v_mfma_f32_16x16x32_bf16 v[28:31], v[116:119], v[68:71], v[28:31]
  v_perm_b32 v112, v22, v22, v8
  v_perm_b32 v113, v22, v22, v10
  v_perm_b32 v114, v22, v22, v12
  v_perm_b32 v115, v22, v22, v14
  s_waitcnt vmcnt(25)
  v_mfma_f32_16x16x32_bf16 v[28:31], v[120:123], v[72:75], v[28:31]
  v_perm_b32 v116, v22, v22, v9
  v_perm_b32 v117, v22, v22, v11
  v_perm_b32 v118, v22, v22, v13
  v_perm_b32 v119, v22, v22, v15
  s_waitcnt vmcnt(24)
  v_mfma_f32_16x16x32_bf16 v[28:31], v[124:127], v[76:79], v[28:31]
  v_perm_b32 v120, v23, v23, v8
  v_perm_b32 v121, v23, v23, v10
  v_perm_b32 v122, v23, v23, v12
  v_perm_b32 v123, v23, v23, v14
  s_waitcnt vmcnt(23)
  v_mfma_f32_16x16x32_bf16 v[28:31], v[112:115], v[80:83], v[28:31]
  v_perm_b32 v124, v23, v23, v9
  v_perm_b32 v125, v23, v23, v11
  v_perm_b32 v126, v23, v23, v13
  v_perm_b32 v127, v23, v23, v15
  s_waitcnt vmcnt(22)
  v_mfma_f32_16x16x32_bf16 v[28:31], v[116:119], v[84:87], v[28:31]
  v_perm_b32 v112, v24, v24, v8
  v_perm_b32 v113, v24, v24, v10
  v_perm_b32 v114, v24, v24, v12
  v_perm_b32 v115, v24, v24, v14
  s_waitcnt vmcnt(21)
  v_mfma_f32_16x16x32_bf16 v[28:31], v[120:123], v[88:91], v[28:31]
  v_perm_b32 v116, v24, v24, v9
  v_perm_b32 v117, v24, v24, v11
  v_perm_b32 v118, v24, v24, v13
  v_perm_b32 v119, v24, v24, v15
  s_waitcnt vmcnt(20)
  v_mfma_f32_16x16x32_bf16 v[28:31], v[124:127], v[92:95], v[28:31]
  v_perm_b32 v120, v25, v25, v8
  v_perm_b32 v121, v25, v25, v10
  v_perm_b32 v122, v25, v25, v12
  v_perm_b32 v123, v25, v25, v14
  s_waitcnt vmcnt(19)
  v_mfma_f32_16x16x32_bf16 v[28:31], v[112:115], v[96:99], v[28:31]
  v_perm_b32 v124, v25, v25, v9
  v_perm_b32 v125, v25, v25, v11
  v_perm_b32 v126, v25, v25, v13
  v_perm_b32 v127, v25, v25, v15
  s_waitcnt vmcnt(18)
  v_mfma_f32_16x16x32_bf16 v[28:31], v[116:119], v[100:103], v[28:31]
  s_waitcnt vmcnt(17)
  v_mfma_f32_16x16x32_bf16 v[28:31], v[120:123], v[104:107], v[28:31]
  s_waitcnt vmcnt(16)
  v_mfma_f32_16x16x32_bf16 v[28:31], v[124:127], v[108:111], v[28:31]
  v_mov_b32 v33, s60
  v_mov_b32 v35, s61
  v_mov_b32 v6, 0
  v_mov_b32 v10, s60
  v_mov_b32 v11, s61
  ds_write_b64 v6, v[10:11] offset:392
  s_nop 1
  v_mov_b32_dpp v28, v28 row_ror:8 row_mask:0xc bank_mask:0xf
  v_mov_b32_dpp v29, v29 row_ror:8 row_mask:0xc bank_mask:0xf
  v_mov_b32_dpp v30, v30 row_ror:8 row_mask:0xc bank_mask:0xf
  v_mov_b32_dpp v31, v31 row_ror:8 row_mask:0xc bank_mask:0xf
  s_nop 0
  v_permlane32_swap_b32 v28, v30
  v_permlane32_swap_b32 v29, v31
  v_add_f32 v32, v28, v30
  v_add_f32 v34, v29, v31
  s_mov_b64 exec, s[44:45]
  buffer_store_dwordx4 v[32:35], v4, s[32:35], s46 offen sc1
  s_mov_b64 exec, -1
  v_lshlrev_b32 v4, 4, v0
  s_lshl_b32 s42, s20, 12
  s_add_u32 s42, s42, 131072
  v_lshlrev_b32 v9, 2, v0
  v_mov_b32 v8, 1
  s_sleep 24
L_qg:
  buffer_load_dwordx4 v[40:43], v4, s[32:35], s42 offen offset:0 sc1
  buffer_load_dwordx4 v[44:47], v4, s[32:35], s42 offen offset:1024 sc1
  buffer_load_dwordx4 v[48:51], v4, s[32:35], s42 offen offset:2048 sc1
  buffer_load_dwordx4 v[52:55], v4, s[32:35], s42 offen offset:3072 sc1
  s_waitcnt vmcnt(0)
  v_xor_b32 v5, s60, v41
  v_bitop3_b32 v5, v43, s61, v5 bitop3:0xbe
  v_bitop3_b32 v5, v45, s60, v5 bitop3:0xbe
  v_bitop3_b32 v5, v47, s61, v5 bitop3:0xbe
  v_bitop3_b32 v5, v49, s60, v5 bitop3:0xbe
  v_bitop3_b32 v5, v51, s61, v5 bitop3:0xbe
  v_bitop3_b32 v5, v53, s60, v5 bitop3:0xbe
  v_bitop3_b32 v5, v55, s61, v5 bitop3:0xbe
  v_cmp_ne_u32 vcc, 0, v5
  s_cbranch_vccz L_qg_done
  s_sleep 2
  s_sub_u32 s59, s59, 1
  s_cmp_gt_i32 s59, 0
  s_cbranch_scc1 L_qg
L_qg_done:
  v_add_f32 v40, v40, v44
  v_add_f32 v42, v42, v46
  v_add_f32 v48, v48, v52
  v_add_f32 v50, v50, v54
  v_add_f32 v40, v40, v48
  v_add_f32 v42, v42, v50
  v_cvt_pk_bf16_f32 v40, v40, v42
  ds_write_b32 v9, v40 offset:0
  s_waitcnt lgkmcnt(0)
  ds_write_b32 v6, v8 offset:384
  s_setprio 0
  s_mov_b32 s42, 0x05040100
  s_mov_b32 s43, 0x07060302
  v_perm_b32 v20, v129, v128, s42
  v_perm_b32 v129, v129, v128, s43
  v_mov_b32 v128, v20
  v_perm_b32 v21, v131, v130, s42
  v_perm_b32 v131, v131, v130, s43
  v_mov_b32 v130, v21
  v_perm_b32 v20, v133, v132, s42
  v_perm_b32 v133, v133, v132, s43
  v_mov_b32 v132, v20
  v_perm_b32 v21, v135, v134, s42
  v_perm_b32 v135, v135, v134, s43
  v_mov_b32 v134, v21
  v_perm_b32 v20, v137, v136, s42
  v_perm_b32 v137, v137, v136, s43
  v_mov_b32 v136, v20
  v_perm_b32 v21, v139, v138, s42
  v_perm_b32 v139, v139, v138, s43
  v_mov_b32 v138, v21
  v_perm_b32 v20, v141, v140, s42
  v_perm_b32 v141, v141, v140, s43
  v_mov_b32 v140, v20
  v_perm_b32 v21, v143, v142, s42
  v_perm_b32 v143, v143, v142, s43
  v_mov_b32 v142, v21
  v_and_b32 v2, 15, v0
  v_lshlrev_b32 v2, 3, v2
  v_lshlrev_b32 v3, 3, v0
  v_lshlrev_b32 v10, 4, v0
  v_lshrrev_b32 v9, 3, v0
  v_and_b32 v11, 7, v0
  v_lshlrev_b32 v9, 10, v9
  v_lshl_add_u32 v9, v11, 4, v9
  s_lshl_b32 s46, s2, 10
  s_add_u32 s46, s46, 262144
  s_mul_i32 s45, s20, 8192
  s_lshl_b32 s43, s21, 7
  s_add_u32 s45, s45, s43
  s_add_u32 s45, s45, 524288
  s_mov_b32 s62, 1040356334
  v_mov_b32 v13, s60
  v_mov_b32 v15, s61
  v_mov_b32 v17, s60
  v_mov_b32 v19, s61
  v_mov_b32 v12, 0
  v_mov_b32 v14, 0
  s_lshl_b32 s47, s2, 4
  s_add_u32 s47, s47, 98304
  s_lshl_b32 s44, s22, 3
  v_lshrrev_b32 v65, 3, v0
  v_and_b32 v68, 7, v0
  v_add_u32 v65, s44, v65
  v_mul_u32_u24 v65, 32768, v65
  v_lshl_add_u32 v65, v68, 4, v65
  s_mul_i32 s54, s20, 8
  s_add_u32 s54, s54, s3
  s_lshl_b32 s54, s54, 7
  s_add_u32 s54, s54, 1048576
  v_mov_b32 v68, 0
  v_mov_b32 v69, s60
  v_mov_b32 v70, 0
  v_mov_b32 v71, s61
  v_mov_b32 v67, 0
  v_and_b32 v20, 7, v0
  v_lshrrev_b32 v21, 3, v0
  v_lshlrev_b32 v22, 10, v20
  v_lshl_add_u32 v22, v21, 4, v22
  v_lshlrev_b32 v23, 7, v20
  v_lshlrev_b32 v21, 2, v21
  s_mul_i32 s52, s3, 128
  s_lshl_b32 s43, s20, 13
  s_add_u32 s52, s52, s43
  s_add_u32 s52, s52, 262144
  s_mul_i32 s53, s20, 8
  s_add_u32 s53, s53, s3
  s_lshl_b32 s53, s53, 10
  s_add_u32 s53, s53, 524288
  v_lshlrev_b32 v23, 4, v20
  s_lshl_b32 s53, s20, 7
  s_add_u32 s53, s53, 98304
  s_lshl_b32 s45, s2, 4
  s_add_u32 s45, s45, 524288
  s_barrier
  ds_read_b64 v[4:5], v2 offset:256
  ds_read_b64 v[32:33], v3 offset:768
  ds_read_b64 v[34:35], v3 offset:1280
  ds_read_b64 v[36:37], v3 offset:1792
  ds_read_b64 v[38:39], v3 offset:2304
  ds_read_b64 v[40:41], v3 offset:2816
  ds_read_b64 v[42:43], v3 offset:3328
  ds_read_b64 v[44:45], v3 offset:3840
  ds_read_b64 v[46:47], v3 offset:4352
  ds_read_b64 v[48:49], v3 offset:4864
  ds_read_b64 v[50:51], v3 offset:5376
  ds_read_b64 v[52:53], v3 offset:5888
  ds_read_b64 v[54:55], v3 offset:6400
  ds_read_b64 v[56:57], v3 offset:6912
  ds_read_b64 v[58:59], v3 offset:7424
  ds_read_b64 v[60:61], v3 offset:7936
  ds_read_b64 v[62:63], v3 offset:8448
  s_waitcnt lgkmcnt(15)
  v_max_f32_dpp v16, v4, v4 row_ror:8 row_mask:0xf bank_mask:0xf
  s_nop 1
  v_max_f32_dpp v16, v16, v16 row_ror:4 row_mask:0xf bank_mask:0xf
  s_nop 1
  v_max_f32_dpp v16, v16, v16 row_ror:2 row_mask:0xf bank_mask:0xf
  s_nop 1
  v_max_f32_dpp v16, v16, v16 row_ror:1 row_mask:0xf bank_mask:0xf
  v_sub_f32 v8, v4, v16
  v_mul_f32 v8, s62, v8
  v_exp_f32 v8, v8
  s_waitcnt lgkmcnt(0)
  v_mul_f32 v18, v8, v5
  v_fmac_f32_dpp v12, v8, v32 row_newbcast:0 row_mask:0xf bank_mask:0xf
  v_fmac_f32_dpp v14, v8, v33 row_newbcast:0 row_mask:0xf bank_mask:0xf
  v_add_f32_dpp v18, v18, v18 row_ror:8 row_mask:0xf bank_mask:0xf
  v_fmac_f32_dpp v12, v8, v34 row_newbcast:1 row_mask:0xf bank_mask:0xf
  v_fmac_f32_dpp v14, v8, v35 row_newbcast:1 row_mask:0xf bank_mask:0xf
  v_add_f32_dpp v18, v18, v18 row_ror:4 row_mask:0xf bank_mask:0xf
  v_fmac_f32_dpp v12, v8, v36 row_newbcast:2 row_mask:0xf bank_mask:0xf
  v_fmac_f32_dpp v14, v8, v37 row_newbcast:2 row_mask:0xf bank_mask:0xf
  v_add_f32_dpp v18, v18, v18 row_ror:2 row_mask:0xf bank_mask:0xf
  v_fmac_f32_dpp v12, v8, v38 row_newbcast:3 row_mask:0xf bank_mask:0xf
  v_fmac_f32_dpp v14, v8, v39 row_newbcast:3 row_mask:0xf bank_mask:0xf
  v_add_f32_dpp v18, v18, v18 row_ror:1 row_mask:0xf bank_mask:0xf
  v_fmac_f32_dpp v12, v8, v40 row_newbcast:4 row_mask:0xf bank_mask:0xf
  v_fmac_f32_dpp v14, v8, v41 row_newbcast:4 row_mask:0xf bank_mask:0xf
  s_mov_b64 exec, 1
  buffer_store_dwordx4 v[16:19], v9, s[32:35], s47 offen sc1
  s_mov_b64 exec, -1
  v_fmac_f32_dpp v12, v8, v42 row_newbcast:5 row_mask:0xf bank_mask:0xf
  v_fmac_f32_dpp v14, v8, v43 row_newbcast:5 row_mask:0xf bank_mask:0xf
  v_fmac_f32_dpp v12, v8, v44 row_newbcast:6 row_mask:0xf bank_mask:0xf
  v_fmac_f32_dpp v14, v8, v45 row_newbcast:6 row_mask:0xf bank_mask:0xf
  v_fmac_f32_dpp v12, v8, v46 row_newbcast:7 row_mask:0xf bank_mask:0xf
  v_fmac_f32_dpp v14, v8, v47 row_newbcast:7 row_mask:0xf bank_mask:0xf
  v_fmac_f32_dpp v12, v8, v48 row_newbcast:8 row_mask:0xf bank_mask:0xf
  v_fmac_f32_dpp v14, v8, v49 row_newbcast:8 row_mask:0xf bank_mask:0xf
  v_fmac_f32_dpp v12, v8, v50 row_newbcast:9 row_mask:0xf bank_mask:0xf
  v_fmac_f32_dpp v14, v8, v51 row_newbcast:9 row_mask:0xf bank_mask:0xf
  v_fmac_f32_dpp v12, v8, v52 row_newbcast:10 row_mask:0xf bank_mask:0xf
  v_fmac_f32_dpp v14, v8, v53 row_newbcast:10 row_mask:0xf bank_mask:0xf
  v_fmac_f32_dpp v12, v8, v54 row_newbcast:11 row_mask:0xf bank_mask:0xf
  v_fmac_f32_dpp v14, v8, v55 row_newbcast:11 row_mask:0xf bank_mask:0xf
  v_fmac_f32_dpp v12, v8, v56 row_newbcast:12 row_mask:0xf bank_mask:0xf
  v_fmac_f32_dpp v14, v8, v57 row_newbcast:12 row_mask:0xf bank_mask:0xf
  v_fmac_f32_dpp v12, v8, v58 row_newbcast:13 row_mask:0xf bank_mask:0xf
  v_fmac_f32_dpp v14, v8, v59 row_newbcast:13 row_mask:0xf bank_mask:0xf
  v_fmac_f32_dpp v12, v8, v60 row_newbcast:14 row_mask:0xf bank_mask:0xf
  v_fmac_f32_dpp v14, v8, v61 row_newbcast:14 row_mask:0xf bank_mask:0xf
  v_fmac_f32_dpp v12, v8, v62 row_newbcast:15 row_mask:0xf bank_mask:0xf
  v_fmac_f32_dpp v14, v8, v63 row_newbcast:15 row_mask:0xf bank_mask:0xf
  buffer_store_dwordx4 v[12:15], v10, s[32:35], s46 offen sc1
  buffer_load_dwordx4 v[76:79], v23, s[32:35], s53 offen sc1
  buffer_load_dwordx4 v[80:83], v22, s[32:35], s52 offen offset:0 sc1
  s_sleep 2
  buffer_load_dwordx4 v[84:87], v23, s[32:35], s53 offen sc1
  buffer_load_dwordx4 v[88:91], v22, s[32:35], s52 offen offset:0 sc1
  s_sleep 2
  buffer_load_dwordx4 v[92:95], v23, s[32:35], s53 offen sc1
  buffer_load_dwordx4 v[96:99], v22, s[32:35], s52 offen offset:0 sc1
  s_sleep 2
L_h1:
  buffer_load_dwordx4 v[100:103], v23, s[32:35], s53 offen sc1
  buffer_load_dwordx4 v[104:107], v22, s[32:35], s52 offen offset:0 sc1
  s_waitcnt vmcnt(6)
  v_xor_b32 v7, s60, v77
  v_bitop3_b32 v7, v79, s61, v7 bitop3:0xbe
  v_bitop3_b32 v7, v81, s60, v7 bitop3:0xbe
  v_bitop3_b32 v7, v83, s61, v7 bitop3:0xbe
  v_cmp_ne_u32 vcc, 0, v7
  s_cbranch_vccz L_h1_0
  buffer_load_dwordx4 v[76:79], v23, s[32:35], s53 offen sc1
  buffer_load_dwordx4 v[80:83], v22, s[32:35], s52 offen offset:0 sc1
  s_waitcnt vmcnt(6)
  v_xor_b32 v7, s60, v85
  v_bitop3_b32 v7, v87, s61, v7 bitop3:0xbe
  v_bitop3_b32 v7, v89, s60, v7 bitop3:0xbe
  v_bitop3_b32 v7, v91, s61, v7 bitop3:0xbe
  v_cmp_ne_u32 vcc, 0, v7
  s_cbranch_vccz L_h1_1
  buffer_load_dwordx4 v[84:87], v23, s[32:35], s53 offen sc1
  buffer_load_dwordx4 v[88:91], v22, s[32:35], s52 offen offset:0 sc1
  s_waitcnt vmcnt(6)
  v_xor_b32 v7, s60, v93
  v_bitop3_b32 v7, v95, s61, v7 bitop3:0xbe
  v_bitop3_b32 v7, v97, s60, v7 bitop3:0xbe
  v_bitop3_b32 v7, v99, s61, v7 bitop3:0xbe
  v_cmp_ne_u32 vcc, 0, v7
  s_cbranch_vccz L_h1_2
  buffer_load_dwordx4 v[92:95], v23, s[32:35], s53 offen sc1
  buffer_load_dwordx4 v[96:99], v22, s[32:35], s52 offen offset:0 sc1
  s_waitcnt vmcnt(6)
  v_xor_b32 v7, s60, v101
  v_bitop3_b32 v7, v103, s61, v7 bitop3:0xbe
  v_bitop3_b32 v7, v105, s60, v7 bitop3:0xbe
  v_bitop3_b32 v7, v107, s61, v7 bitop3:0xbe
  v_cmp_ne_u32 vcc, 0, v7
  s_cbranch_vccz L_h1_3
  s_sub_u32 s59, s59, 1
  s_cmp_gt_i32 s59, 0
  s_cbranch_scc1 L_h1
L_h1_0:
  v_max_f32_dpp v31, v76, v76 quad_perm:[1,0,3,2] row_mask:0xf bank_mask:0xf
  v_mov_b32 v32, v76
  v_mov_b32 v33, v78
  v_mov_b32 v34, v80
  v_mov_b32 v35, v82
  s_branch L_h1_ok
L_h1_1:
  v_max_f32_dpp v31, v84, v84 quad_perm:[1,0,3,2] row_mask:0xf bank_mask:0xf
  v_mov_b32 v32, v84
  v_mov_b32 v33, v86
  v_mov_b32 v34, v88
  v_mov_b32 v35, v90
  s_branch L_h1_ok
L_h1_2:
  v_max_f32_dpp v31, v92, v92 quad_perm:[1,0,3,2] row_mask:0xf bank_mask:0xf
  v_mov_b32 v32, v92
  v_mov_b32 v33, v94
  v_mov_b32 v34, v96
  v_mov_b32 v35, v98
  s_branch L_h1_ok
L_h1_3:
  v_max_f32_dpp v31, v100, v100 quad_perm:[1,0,3,2] row_mask:0xf bank_mask:0xf
  v_mov_b32 v32, v100
  v_mov_b32 v33, v102
  v_mov_b32 v34, v104
  v_mov_b32 v35, v106
L_h1_ok:
  v_max_f32_dpp v31, v31, v31 quad_perm:[2,3,0,1] row_mask:0xf bank_mask:0xf
  s_nop 1
  v_max_f32_dpp v31, v31, v31 row_half_mirror row_mask:0xf bank_mask:0xf
  v_sub_f32 v31, v32, v31
  v_mul_f32 v31, s62, v31
  v_exp_f32 v31, v31
  s_nop 0
  v_mul_f32 v33, v31, v33
  v_mul_f32 v34, v31, v34
  v_mul_f32 v35, v31, v35
  v_add_f32_dpp v33, v33, v33 quad_perm:[1,0,3,2] row_mask:0xf bank_mask:0xf
  v_add_f32_dpp v34, v34, v34 quad_perm:[1,0,3,2] row_mask:0xf bank_mask:0xf
  v_add_f32_dpp v35, v35, v35 quad_perm:[1,0,3,2] row_mask:0xf bank_mask:0xf
  v_add_f32_dpp v33, v33, v33 quad_perm:[2,3,0,1] row_mask:0xf bank_mask:0xf
  v_add_f32_dpp v34, v34, v34 quad_perm:[2,3,0,1] row_mask:0xf bank_mask:0xf
  v_add_f32_dpp v35, v35, v35 quad_perm:[2,3,0,1] row_mask:0xf bank_mask:0xf
  v_add_f32_dpp v33, v33, v33 row_half_mirror row_mask:0xf bank_mask:0xf
  v_add_f32_dpp v34, v34, v34 row_half_mirror row_mask:0xf bank_mask:0xf
  v_add_f32_dpp v35, v35, v35 row_half_mirror row_mask:0xf bank_mask:0xf
  v_rcp_f32 v33, v33
  s_nop 0
  v_mul_f32 v34, v34, v33
  v_mul_f32 v35, v35, v33
  v_cvt_pk_bf16_f32 v34, v34, v35
  ds_write_b32 v21, v34 offset:512
  s_waitcnt lgkmcnt(0)
  s_barrier
  ds_read_b128 v[40:43], v67 offset:512
  ds_read_b128 v[44:47], v67 offset:528
  s_waitcnt lgkmcnt(1)
  v_dot2c_f32_bf16 v68, v40, v128
  v_dot2c_f32_bf16 v70, v40, v129
  v_dot2c_f32_bf16 v68, v41, v130
  v_dot2c_f32_bf16 v70, v41, v131
  v_dot2c_f32_bf16 v68, v42, v132
  v_dot2c_f32_bf16 v70, v42, v133
  v_dot2c_f32_bf16 v68, v43, v134
  v_dot2c_f32_bf16 v70, v43, v135
  s_waitcnt lgkmcnt(0)
  v_dot2c_f32_bf16 v68, v44, v136
  v_dot2c_f32_bf16 v70, v44, v137
  v_dot2c_f32_bf16 v68, v45, v138
  v_dot2c_f32_bf16 v70, v45, v139
  v_dot2c_f32_bf16 v68, v46, v140
  v_dot2c_f32_bf16 v70, v46, v141
  v_dot2c_f32_bf16 v68, v47, v142
  v_dot2c_f32_bf16 v70, v47, v143
  s_nop 2
  buffer_store_dwordx4 v[68:71], v65, s[32:35], s54 offen sc1
L_hcons:
  s_cmp_ge_u32 s57, 40
  s_cbranch_scc1 L_fin
  s_mov_b32 s36, s14
  s_mov_b32 s37, s15
  s_mov_b32 s38, 1280
  s_mov_b32 s39, 0x20000
  v_lshlrev_b32 v4, 2, v0
  v_lshlrev_b32 v5, 1, v0
  s_lshl_b32 s46, s57, 5
  s_mov_b64 exec, 0xffff
  s_barrier
  ds_read_b32 v8, v4 offset:0
  ds_read_b32 v9, v4 offset:64
  ds_read_b32 v10, v4 offset:128
  ds_read_b32 v11, v4 offset:192
  s_waitcnt lgkmcnt(2)
  v_add_f32 v8, v8, v9
  s_waitcnt lgkmcnt(0)
  v_add_f32 v10, v10, v11
  v_add_f32 v8, v8, v10
  v_cvt_pk_bf16_f32 v8, v8, v8
  buffer_store_short v8, v5, s[36:39], s46 offen
  s_cmp_lg_u32 s57, 0
  s_cbranch_scc1 L_fin
  s_mov_b32 s43, 65536
  v_mov_b32 v8, s61
  v_mov_b32 v9, 0
  s_mov_b64 exec, 1
  buffer_store_dword v8, v9, s[32:35], s43 offen sc1
L_fin:
L_end:
  s_endpgm
.section .rodata,"a"
.p2align 6
.amdhsa_kernel standalone__gqa_block_cached__decode_kernel
.amdhsa_next_free_vgpr 160
.amdhsa_next_free_sgpr 80
.amdhsa_accum_offset 160
.amdhsa_float_denorm_mode_32 3
.amdhsa_group_segment_fixed_size 0
.amdhsa_kernarg_size 64
.amdhsa_user_sgpr_count 2
.amdhsa_user_sgpr_kernarg_segment_ptr 1
.amdhsa_system_sgpr_workgroup_id_x 1
.end_amdhsa_kernel
```
